```python
import torch

def _softmax(x, axis=-1):
    return torch.softmax(x, dim=axis)
def _gelu(x):
    return torch.nn.functional.gelu(x, approximate="tanh")
def _silu(x):
    return torch.nn.functional.silu(x)
def _sigmoid(x):
    return torch.sigmoid(x)
def _layernorm(x, axis=-1, eps=1e-5):
    m = x.mean(dim=axis, keepdim=True)
    v = x.var(dim=axis, keepdim=True, unbiased=False)
    return (x - m) / torch.sqrt(v + eps)
def _scatter_add(tgt, idx, src, axis=0):
    return tgt.clone().index_add_(axis, idx, src)
def _segment_sum(src, seg, n):
    out = torch.zeros((n,) + src.shape[1:], dtype=src.dtype)
    return out.index_add_(0, seg, src)
def _pad(x, pw):
    flat = tuple(v for pair in reversed(pw) for v in pair)
    return torch.nn.functional.pad(x, flat)

kernel_name = 'interleave_layers__sliding_block__glu_gated_swiglu__prompt'

def setup_inputs():

    _w = (lambda a: (lambda t: t.to(torch.bfloat16) if t.is_floating_point() else t)(torch.as_tensor(a)))
    def _A_setup():
        B, S, D = 1, 2048, 512
        return {
            "x": _w((lambda *s: torch.randn(*s, dtype=torch.bfloat16) * 0.05)(B, S, D)),
            "wqkv": _w((lambda *s: torch.randn(*s, dtype=torch.bfloat16) * 0.05)(D, 3 * D)),
            "wo": _w((lambda *s: torch.randn(*s, dtype=torch.bfloat16) * 0.05)(D, D)),
        }
    _A_in = _A_setup()

    def _B_setup():
        B, S, D, F = 1, 2048, 512, 1376
        return {
            "x": _w((lambda *s: torch.randn(*s, dtype=torch.bfloat16) * 0.05)(B, S, D)),
            "w1": _w((lambda *s: torch.randn(*s, dtype=torch.bfloat16) * 0.8)(D, F) * (2.0 / D) ** 0.5),
            "w3": _w((lambda *s: torch.randn(*s, dtype=torch.bfloat16) * 0.8)(D, F) * (2.0 / D) ** 0.5),
            "w2": _w((lambda *s: torch.randn(*s, dtype=torch.bfloat16) * 0.8)(F, D) * (2.0 / F) ** 0.5),
        }
    _B_in = _B_setup()

    return {
        "A_x": _A_in["x"],
        "A_wqkv": _A_in["wqkv"],
        "A_wo": _A_in["wo"],
        "B_x": _B_in["x"],
        "B_w1": _B_in["w1"],
        "B_w3": _B_in["w3"],
        "B_w2": _B_in["w2"],
    }

def reference(A_x, A_wqkv, A_wo, B_x, B_w1, B_w3, B_w2):
    def _A_ref(x, wqkv, wo):
        B, S, D = x.shape
        H = 32; Dh = D // H; W = 256
        qkv = (lambda x, *d: x.permute(*d))((x @ wqkv).reshape(B, S, 3, H, Dh), 2, 0, 3, 1, 4)
        q, k, v = qkv[0], qkv[1], qkv[2]
        scores = torch.einsum("bhqd,bhkd->bhqk", q, k) * (Dh ** -0.5)
        idx = torch.arange(S)
        mask = (idx[:, None] - idx[None, :] >= 0) & (idx[:, None] - idx[None, :] < W)
        scores = torch.where(mask[None, None], scores, -1e9)
        p = _softmax(scores, axis=-1)
        o = torch.einsum("bhqk,bhkd->bhqd", p, v)
        return (lambda x, *d: x.permute(*d))(o, 0, 2, 1, 3).reshape(B, S, D) @ wo

    def _B_ref(x, w1, w3, w2):
        gate = torch.einsum("bsd,df->bsf", x, w1)
        up = torch.einsum("bsd,df->bsf", x, w3)
        h = _silu(gate) * up
        out = torch.einsum("bsf,fd->bsd", h, w2)
        return out

    x = A_x
    x = x + _A_ref(_layernorm(x, axis=-1), A_wqkv, A_wo)
    x = x + _B_ref(_layernorm(x, axis=-1), B_w1, B_w3, B_w2)
    x = x + _A_ref(_layernorm(x, axis=-1), A_wqkv, A_wo)
    x = x + _B_ref(_layernorm(x, axis=-1), B_w1, B_w3, B_w2)
    return x
```

```asm
; @launch grid=(256,1,1) block=(256,1,1) lds=163840
.amdgcn_target "amdgcn-amd-amdhsa--gfx950"
.text
.globl interleave_layers__sliding_block__glu_gated_swiglu__prompt_kernel
.p2align 8
.type interleave_layers__sliding_block__glu_gated_swiglu__prompt_kernel,@function
interleave_layers__sliding_block__glu_gated_swiglu__prompt_kernel:
s_cmp_ge_u32 s2, 256
s_cbranch_scc1 M_END
s_load_dwordx16 s[64:79], s[0:1], 0
s_load_dwordx4 s[80:83], s[0:1], 64
v_lshrrev_b32 v1, 6, v0
v_and_b32 v0, 63, v0
v_readfirstlane_b32 s16, v1
s_and_b32 s14, s2, 7
s_lshl_b32 s14, s14, 1
s_lshr_b32 s15, s2, 7
s_add_u32 s14, s14, s15
s_lshr_b32 s15, s2, 3
s_and_b32 s15, s15, 15
v_lshlrev_b32 v1, 4, v0
v_and_b32 v4, 7, v0
v_lshrrev_b32 v5, 3, v0
v_lshlrev_b32 v6, 10, v4
v_lshl_add_u32 v6, v5, 4, v6
s_lshl_b32 s41, s14, 17
s_lshl_b32 s24, s15, 13
s_add_u32 s24, s24, s41
s_lshl_b32 s25, s16, 8
s_add_u32 s27, s24, s25
s_lshl_b32 s22, s14, 7
s_lshl_b32 s47, s14, 2
s_lshl_b32 s43, s15, 2
s_add_u32 s43, s43, s16
v_mov_b32 v10, 0
v_mov_b32 v11, 0
v_lshlrev_b32 v9, 11, v0
s_lshl_b32 s28, s14, 4
s_add_u32 s28, s28, s15
s_lshl_b32 s28, s28, 2
s_add_u32 s28, s28, s16
s_lshl_b32 s28, s28, 7
s_add_u32 s28, s28, 65536
s_add_u32 s26, s28, 131072
s_lshl_b32 s29, s16, 8
s_add_u32 s29, s29, s2
s_and_b32 s30, s29, 63
s_lshr_b32 s31, s29, 6
s_mov_b32 s59, 0x20000
s_mov_b32 s39, 1024
v_lshrrev_b32 v20, 2, v0
v_lshlrev_b32 v20, 9, v20
v_and_b32 v24, 1, v0
v_lshrrev_b32 v25, 4, v0
v_lshrrev_b32 v26, 5, v0
v_and_b32 v27, 2, v0
v_and_b32 v28, 0x1f0, v1
s_waitcnt lgkmcnt(0)
s_getpc_b64 s[60:61]
CODE_PC:
s_lshl_b32 s24, s16, 13
v_lshlrev_b32 v99, 7, v0
v_add_u32 v99, s24, v99
v_mov_b32 v100, v99
v_mov_b32 v101, s61
v_add_co_u32 v100, vcc, s60, v100
s_nop 1
v_addc_co_u32 v101, vcc, 0, v101, vcc
v_cmp_gt_u32 vcc, CODE_END-CODE_PC, v99
s_nop 0
s_and_b64 exec, exec, vcc
global_load_dword v102, v[100:101], off
s_mov_b64 exec, -1
s_mov_b32 s52, s64
s_mov_b32 s53, s65
s_mov_b32 s54, 2097152
s_mov_b32 s55, 0x20000
buffer_load_dwordx4 v[12:15], v6, s[52:55], s27 offen
buffer_load_dwordx4 v[16:19], v6, s[52:55], s27 offen offset:128
s_mov_b32 s4, s82
s_mov_b32 s5, s83
s_mov_b32 s6, 268435456
s_mov_b32 s7, 0x20000
s_cmp_eq_u32 s43, 3
s_cselect_b32 s24, s22, 0x40000000
s_mov_b32 exec_hi, 0
buffer_store_dword v10, v9, s[4:7], s24 offen sc1
s_mov_b64 exec, 1
buffer_store_dword v10, off, s[4:7], s28 sc1
buffer_store_dword v10, off, s[4:7], s26 sc1
s_lshl_b32 s3, s14, 8
s_add_u32 s3, s3, 0x60000
s_lshl_b32 s24, s15, 4
s_add_u32 s40, s24, s3
buffer_store_dword v10, off, s[4:7], s40 sc1
s_mov_b64 exec, -1
s_cmp_ge_u32 s29, 640
s_cbranch_scc1 I_W2
s_cmp_ge_u32 s29, 256
s_cbranch_scc1 I_W13
s_cmp_ge_u32 s29, 192
s_cbranch_scc1 I_WO
s_mov_b32 s56, s66
s_mov_b32 s57, s67
s_mov_b32 s58, 1572864
s_mov_b32 s39, 3072
s_lshl_b32 s32, s31, 15
s_add_u32 s32, s32, 1048576
s_mov_b32 s34, 98304
s_branch I_M32
I_WO:
s_mov_b32 s31, 0
s_mov_b32 s56, s68
s_mov_b32 s57, s69
s_mov_b32 s58, 524288
s_lshl_b32 s32, s30, 8
s_add_u32 s32, s32, 2621440
s_mov_b32 s33, 65536
v_and_b32 v21, 3, v0
v_lshl_add_u32 v20, v21, 6, v20
v_add_u32 v21, 256, v20
v_and_b32 v22, 0xf0, v1
v_lshl_add_u32 v22, v25, 14, v22
s_branch I_GO
I_W13:
s_sub_u32 s31, s31, 4
s_cmp_ge_u32 s31, 3
s_cselect_b32 s56, s74, s72
s_cselect_b32 s57, s75, s73
s_cselect_b32 s24, 128, 0
s_cselect_b32 s25, 3, 0
s_sub_u32 s31, s31, s25
s_mov_b32 s58, 1409024
s_mov_b32 s39, 2752
s_lshl_b32 s32, s31, 20
s_add_u32 s32, s32, s24
s_lshl_b32 s24, s30, 9
s_add_u32 s32, s32, s24
s_add_u32 s32, s32, 3145728
s_mov_b32 s33, 131072
v_lshrrev_b32 v20, 1, v0
s_lshl_b32 s24, s31, 5
v_add_u32 v21, s24, v20
v_mul_u32_u24 v22, 43691, v21
v_lshrrev_b32 v22, 17, v22
v_mul_u32_u24 v22, 3, v22
v_sub_u32 v21, v21, v22
v_cmp_eq_u32 vcc, 1, v21
v_lshlrev_b32 v20, 8, v20
v_mov_b32 v21, 64
v_mov_b32 v22, 128
v_cndmask_b32 v27, v21, v22, vcc
v_cndmask_b32 v28, v22, v21, vcc
v_mul_u32_u24 v27, v24, v27
v_add_u32 v20, v20, v27
v_add_u32 v21, v20, v28
v_and_b32 v22, 0x70, v1
v_and_b32 v27, 1, v5
v_lshl_add_u32 v22, v27, 8, v22
v_lshl_add_u32 v22, v25, 15, v22
s_branch I_GO
I_W2:
s_sub_u32 s30, s29, 640
s_mov_b32 s31, 0
s_mov_b32 s56, s76
s_mov_b32 s57, s77
s_mov_b32 s58, 1409024
s_mov_b32 s32, 6291456
s_mov_b32 s34, 88064
s_cmp_ge_u32 s29, 812
s_cselect_b32 s32, 0x40000000, s32
I_M32:
s_lshl_b32 s24, s30, 9
s_add_u32 s32, s32, s24
s_lshl_b32 s33, s34, 1
v_lshl_add_u32 v20, v27, 7, v20
v_lshl_add_u32 v20, v24, 6, v20
v_add_u32 v21, 128, v20
v_mul_lo_u32 v22, v26, s34
v_add_u32 v22, v22, v28
I_GO:
s_mul_i32 s37, s30, s39
s_lshl_b32 s37, s37, 3
s_lshl_b32 s25, s31, 10
s_add_u32 s37, s37, s25
s_cmp_lg_u32 s16, 0
s_cbranch_scc1 I_S0
buffer_load_dwordx4 v[32:35], v1, s[56:59], s37 offen
s_add_u32 s37, s37, s39
buffer_load_dwordx4 v[36:39], v1, s[56:59], s37 offen
s_add_u32 s37, s37, s39
buffer_load_dwordx4 v[40:43], v1, s[56:59], s37 offen
s_add_u32 s37, s37, s39
buffer_load_dwordx4 v[44:47], v1, s[56:59], s37 offen
s_add_u32 s37, s37, s39
buffer_load_dwordx4 v[48:51], v1, s[56:59], s37 offen
s_add_u32 s37, s37, s39
buffer_load_dwordx4 v[52:55], v1, s[56:59], s37 offen
s_add_u32 s37, s37, s39
buffer_load_dwordx4 v[56:59], v1, s[56:59], s37 offen
s_add_u32 s37, s37, s39
buffer_load_dwordx4 v[60:63], v1, s[56:59], s37 offen
I_S0:
s_mov_b32 s48, s80
s_mov_b32 s49, s81
s_mov_b32 s50, 256
s_mov_b32 s51, 0x20000
v_lshlrev_b32 v110, 2, v0
s_mov_b32 s12, s78
s_mov_b32 s13, s79
s_mov_b32 s21, 400000
s_mov_b32 s18, 0
s_mov_b32 s17, 33554432
s_mov_b32 s20, 0
s_mov_b32 s46, 0x3f803f80
v_lshlrev_b32 v9, 3, v0
v_add_u32 v9, 147456, v9
ds_write_b64 v9, v[10:11]
v_lshlrev_b32 v106, 8, v5
v_lshl_add_u32 v106, v4, 4, v106
v_lshrrev_b32 v107, 5, v0
v_lshlrev_b32 v107, 2, v107
v_lshl_add_u32 v107, v4, 3, v107
s_lshr_b32 s24, s15, 1
s_lshl_b32 s24, s24, 14
s_add_u32 s24, s24, s41
s_and_b32 s25, s15, 1
s_lshl_b32 s25, s25, 7
s_add_u32 s24, s24, s25
s_lshl_b32 s25, s16, 12
s_add_u32 s24, s24, s25
s_add_u32 s35, s24, 16777216
s_lshl_b32 s25, s14, 13
s_lshr_b32 s26, s15, 2
s_lshl_b32 s26, s26, 11
s_add_u32 s25, s25, s26
s_and_b32 s26, s15, 3
s_lshl_b32 s26, s26, 6
s_add_u32 s25, s25, s26
s_lshl_b32 s26, s16, 9
s_add_u32 s25, s25, s26
s_add_u32 s36, s25, 18874368
v_and_b32 v24, 15, v0
v_lshlrev_b32 v24, 4, v24
v_lshrrev_b32 v25, 5, v0
v_lshl_add_u32 v24, v25, 8, v24
v_bfe_u32 v26, v0, 4, 1
v_lshl_add_u32 v2, v26, 14, v24
v_mul_u32_u24 v26, 44032, v26
v_add_u32 v3, v26, v24
s_cmp_eq_u32 s14, 1
s_cselect_b32 s19, 4, 0
s_cmp_eq_u32 s14, 0
s_cselect_b32 s19, 8, s19
s_and_b32 s42, s16, 1
s_lshl_b32 s44, s42, 4
s_lshl_b32 s44, 0xffff, s44
s_mov_b32 s45, s44
s_mov_b32 s26, 0x05040100
s_mov_b32 s27, 0x07060302
s_lshl_b32 s24, s16, 13
s_add_u32 s24, s24, 98304
v_add_u32 v20, s24, v20
v_add_u32 v21, s24, v21
v_add_u32 v23, s24, v1
s_waitcnt vmcnt(3)
s_cmp_eq_u32 s43, 3
s_cselect_b32 s24, s47, 0x1000
v_mov_b32 v104, 1
s_mov_b64 exec, 1
buffer_store_dword v104, off, s[48:51], s24 sc1
s_mov_b64 exec, -1
buffer_store_dwordx4 v[12:15], v106, s[4:7], s35 offen sc1
buffer_store_dwordx4 v[16:19], v106, s[4:7], s35 offen offset:2048 sc1
v_lshlrev_b32 v24, 16, v12
v_and_b32 v25, 0xffff0000, v12
v_lshlrev_b32 v26, 16, v13
v_and_b32 v27, 0xffff0000, v13
v_lshlrev_b32 v28, 16, v14
v_and_b32 v29, 0xffff0000, v14
v_lshlrev_b32 v30, 16, v15
v_and_b32 v31, 0xffff0000, v15
v_add_f32 v104, v24, v25
v_mul_f32 v105, v24, v24
v_fmac_f32 v105, v25, v25
v_add_f32 v104, v104, v26
v_fmac_f32 v105, v26, v26
v_add_f32 v104, v104, v27
v_fmac_f32 v105, v27, v27
v_add_f32 v104, v104, v28
v_fmac_f32 v105, v28, v28
v_add_f32 v104, v104, v29
v_fmac_f32 v105, v29, v29
v_add_f32 v104, v104, v30
v_fmac_f32 v105, v30, v30
v_add_f32 v104, v104, v31
v_fmac_f32 v105, v31, v31
s_nop 1
v_permlane32_swap_b32 v104, v105
v_add_f32 v104, v104, v105
v_mov_b32 v105, v104
s_nop 1
v_permlane16_swap_b32 v104, v105
v_add_f32 v104, v104, v105
s_nop 1
v_add_f32_dpp v104, v104, v104 row_ror:8 row_mask:0xf bank_mask:0xf
buffer_store_dword v104, v107, s[4:7], s36 offen offset:0 sc1
v_lshlrev_b32 v24, 16, v16
v_and_b32 v25, 0xffff0000, v16
v_lshlrev_b32 v26, 16, v17
v_and_b32 v27, 0xffff0000, v17
v_lshlrev_b32 v28, 16, v18
v_and_b32 v29, 0xffff0000, v18
v_lshlrev_b32 v30, 16, v19
v_and_b32 v31, 0xffff0000, v19
v_add_f32 v104, v24, v25
v_mul_f32 v105, v24, v24
v_fmac_f32 v105, v25, v25
v_add_f32 v104, v104, v26
v_fmac_f32 v105, v26, v26
v_add_f32 v104, v104, v27
v_fmac_f32 v105, v27, v27
v_add_f32 v104, v104, v28
v_fmac_f32 v105, v28, v28
v_add_f32 v104, v104, v29
v_fmac_f32 v105, v29, v29
v_add_f32 v104, v104, v30
v_fmac_f32 v105, v30, v30
v_add_f32 v104, v104, v31
v_fmac_f32 v105, v31, v31
s_nop 1
v_permlane32_swap_b32 v104, v105
v_add_f32 v104, v104, v105
v_mov_b32 v105, v104
s_nop 1
v_permlane16_swap_b32 v104, v105
v_add_f32 v104, v104, v105
s_nop 1
v_add_f32_dpp v104, v104, v104 row_ror:8 row_mask:0xf bank_mask:0xf
buffer_store_dword v104, v107, s[4:7], s36 offen offset:256 sc1
s_cmp_lg_u32 s16, 0
s_cbranch_scc1 I_S1
s_waitcnt vmcnt(5)
v_perm_b32 v64, v36, v32, s26
v_perm_b32 v65, v44, v40, s26
v_perm_b32 v66, v52, v48, s26
v_perm_b32 v67, v60, v56, s26
ds_write_b128 v20, v[64:67] offset:0
v_perm_b32 v68, v36, v32, s27
v_perm_b32 v69, v44, v40, s27
v_perm_b32 v70, v52, v48, s27
v_perm_b32 v71, v60, v56, s27
ds_write_b128 v20, v[68:71] offset:16
v_perm_b32 v72, v37, v33, s26
v_perm_b32 v73, v45, v41, s26
v_perm_b32 v74, v53, v49, s26
v_perm_b32 v75, v61, v57, s26
ds_write_b128 v20, v[72:75] offset:32
v_perm_b32 v76, v37, v33, s27
v_perm_b32 v77, v45, v41, s27
v_perm_b32 v78, v53, v49, s27
v_perm_b32 v79, v61, v57, s27
ds_write_b128 v20, v[76:79] offset:48
v_perm_b32 v80, v38, v34, s26
v_perm_b32 v81, v46, v42, s26
v_perm_b32 v82, v54, v50, s26
v_perm_b32 v83, v62, v58, s26
ds_write_b128 v21, v[80:83] offset:0
v_perm_b32 v84, v38, v34, s27
v_perm_b32 v85, v46, v42, s27
v_perm_b32 v86, v54, v50, s27
v_perm_b32 v87, v62, v58, s27
ds_write_b128 v21, v[84:87] offset:16
v_perm_b32 v88, v39, v35, s26
v_perm_b32 v89, v47, v43, s26
v_perm_b32 v90, v55, v51, s26
v_perm_b32 v91, v63, v59, s26
ds_write_b128 v21, v[88:91] offset:32
v_perm_b32 v92, v39, v35, s27
v_perm_b32 v93, v47, v43, s27
v_perm_b32 v94, v55, v51, s27
v_perm_b32 v95, v63, v59, s27
ds_write_b128 v21, v[92:95] offset:48
ds_read_b128 v[32:35], v23 offset:0
ds_read_b128 v[36:39], v23 offset:1024
ds_read_b128 v[40:43], v23 offset:2048
ds_read_b128 v[44:47], v23 offset:3072
ds_read_b128 v[48:51], v23 offset:4096
ds_read_b128 v[52:55], v23 offset:5120
ds_read_b128 v[56:59], v23 offset:6144
ds_read_b128 v[60:63], v23 offset:7168
s_waitcnt lgkmcnt(7)
buffer_store_dwordx4 v[32:35], v22, s[4:7], s32 offen sc1
s_add_u32 s32, s32, s33
s_waitcnt lgkmcnt(6)
buffer_store_dwordx4 v[36:39], v22, s[4:7], s32 offen sc1
s_add_u32 s32, s32, s33
s_waitcnt lgkmcnt(5)
buffer_store_dwordx4 v[40:43], v22, s[4:7], s32 offen sc1
s_add_u32 s32, s32, s33
s_waitcnt lgkmcnt(4)
buffer_store_dwordx4 v[44:47], v22, s[4:7], s32 offen sc1
s_add_u32 s32, s32, s33
s_waitcnt lgkmcnt(3)
buffer_store_dwordx4 v[48:51], v22, s[4:7], s32 offen sc1
s_add_u32 s32, s32, s33
s_waitcnt lgkmcnt(2)
buffer_store_dwordx4 v[52:55], v22, s[4:7], s32 offen sc1
s_add_u32 s32, s32, s33
s_waitcnt lgkmcnt(1)
buffer_store_dwordx4 v[56:59], v22, s[4:7], s32 offen sc1
s_add_u32 s32, s32, s33
s_waitcnt lgkmcnt(0)
buffer_store_dwordx4 v[60:63], v22, s[4:7], s32 offen sc1
buffer_load_dword v111, v110, s[48:51], 0 offen sc1
s_waitcnt vmcnt(0)
s_branch I_S3
I_S1:
s_waitcnt vmcnt(0)
I_S3:
s_barrier
s_cmp_lg_u32 s16, 0
s_cbranch_scc1 GS_4
v_cmp_gt_u32 s[96:97], 1, v111
s_nop 0
s_and_b32 s96, s96, 0xffff
s_cbranch_scc0 I_DB
s_mov_b64 exec, 0xffff
POLL_6:
buffer_load_dword v111, v110, s[48:51], 0 offen sc1
s_waitcnt vmcnt(0)
v_cmp_gt_u32 vcc, 1, v111
s_nop 1
s_cbranch_vccz PX_7
s_sub_u32 s21, s21, 1
s_cbranch_scc1 PX_7_t
s_sleep 2
s_branch POLL_6
PX_7_t:
s_mov_b32 s21, 0
PX_7:
s_mov_b64 exec, -1
I_DB:
s_add_u32 s24, s22, 16384
s_mov_b64 exec, 1
v_mov_b32 v111, 1
buffer_atomic_add v111, off, s[4:7], s24 sc0
s_waitcnt vmcnt(0)
v_readfirstlane_b32 s23, v111
s_mov_b64 exec, -1
s_cmp_lg_u32 s23, 15
s_cbranch_scc1 GS_4
v_lshlrev_b32 v109, 7, v0
v_mov_b32 v111, 1
s_mov_b32 s24, 18432
s_mov_b64 exec, 0xffff
buffer_atomic_add v111, v109, s[4:7], s24 offen
s_mov_b64 exec, -1
GS_4:
s_cmp_eq_u32 s16, 0
s_cbranch_scc1 I_S4
s_sleep 2
buffer_load_dwordx4 v[32:35], v1, s[56:59], s37 offen
s_add_u32 s37, s37, s39
buffer_load_dwordx4 v[36:39], v1, s[56:59], s37 offen
s_add_u32 s37, s37, s39
buffer_load_dwordx4 v[40:43], v1, s[56:59], s37 offen
s_add_u32 s37, s37, s39
buffer_load_dwordx4 v[44:47], v1, s[56:59], s37 offen
s_add_u32 s37, s37, s39
buffer_load_dwordx4 v[48:51], v1, s[56:59], s37 offen
s_add_u32 s37, s37, s39
buffer_load_dwordx4 v[52:55], v1, s[56:59], s37 offen
s_add_u32 s37, s37, s39
buffer_load_dwordx4 v[56:59], v1, s[56:59], s37 offen
s_add_u32 s37, s37, s39
buffer_load_dwordx4 v[60:63], v1, s[56:59], s37 offen
I_S4:
buffer_load_dword v108, v106, s[4:7], s35 offen offset:0 sc1
buffer_load_dword v108, v106, s[4:7], s35 offen offset:2048 sc1
s_cmp_eq_u32 s16, 0
s_cbranch_scc1 I_S2
s_waitcnt vmcnt(2)
v_perm_b32 v64, v36, v32, s26
v_perm_b32 v65, v44, v40, s26
v_perm_b32 v66, v52, v48, s26
v_perm_b32 v67, v60, v56, s26
ds_write_b128 v20, v[64:67] offset:0
v_perm_b32 v68, v36, v32, s27
v_perm_b32 v69, v44, v40, s27
v_perm_b32 v70, v52, v48, s27
v_perm_b32 v71, v60, v56, s27
ds_write_b128 v20, v[68:71] offset:16
v_perm_b32 v72, v37, v33, s26
v_perm_b32 v73, v45, v41, s26
v_perm_b32 v74, v53, v49, s26
v_perm_b32 v75, v61, v57, s26
ds_write_b128 v20, v[72:75] offset:32
v_perm_b32 v76, v37, v33, s27
v_perm_b32 v77, v45, v41, s27
v_perm_b32 v78, v53, v49, s27
v_perm_b32 v79, v61, v57, s27
ds_write_b128 v20, v[76:79] offset:48
v_perm_b32 v80, v38, v34, s26
v_perm_b32 v81, v46, v42, s26
v_perm_b32 v82, v54, v50, s26
v_perm_b32 v83, v62, v58, s26
ds_write_b128 v21, v[80:83] offset:0
v_perm_b32 v84, v38, v34, s27
v_perm_b32 v85, v46, v42, s27
v_perm_b32 v86, v54, v50, s27
v_perm_b32 v87, v62, v58, s27
ds_write_b128 v21, v[84:87] offset:16
v_perm_b32 v88, v39, v35, s26
v_perm_b32 v89, v47, v43, s26
v_perm_b32 v90, v55, v51, s26
v_perm_b32 v91, v63, v59, s26
ds_write_b128 v21, v[88:91] offset:32
v_perm_b32 v92, v39, v35, s27
v_perm_b32 v93, v47, v43, s27
v_perm_b32 v94, v55, v51, s27
v_perm_b32 v95, v63, v59, s27
ds_write_b128 v21, v[92:95] offset:48
ds_read_b128 v[32:35], v23 offset:0
ds_read_b128 v[36:39], v23 offset:1024
ds_read_b128 v[40:43], v23 offset:2048
ds_read_b128 v[44:47], v23 offset:3072
ds_read_b128 v[48:51], v23 offset:4096
ds_read_b128 v[52:55], v23 offset:5120
ds_read_b128 v[56:59], v23 offset:6144
ds_read_b128 v[60:63], v23 offset:7168
s_waitcnt lgkmcnt(7)
buffer_store_dwordx4 v[32:35], v22, s[4:7], s32 offen sc1
s_add_u32 s32, s32, s33
s_waitcnt lgkmcnt(6)
buffer_store_dwordx4 v[36:39], v22, s[4:7], s32 offen sc1
s_add_u32 s32, s32, s33
s_waitcnt lgkmcnt(5)
buffer_store_dwordx4 v[40:43], v22, s[4:7], s32 offen sc1
s_add_u32 s32, s32, s33
s_waitcnt lgkmcnt(4)
buffer_store_dwordx4 v[44:47], v22, s[4:7], s32 offen sc1
s_add_u32 s32, s32, s33
s_waitcnt lgkmcnt(3)
buffer_store_dwordx4 v[48:51], v22, s[4:7], s32 offen sc1
s_add_u32 s32, s32, s33
s_waitcnt lgkmcnt(2)
buffer_store_dwordx4 v[52:55], v22, s[4:7], s32 offen sc1
s_add_u32 s32, s32, s33
s_waitcnt lgkmcnt(1)
buffer_store_dwordx4 v[56:59], v22, s[4:7], s32 offen sc1
s_add_u32 s32, s32, s33
s_waitcnt lgkmcnt(0)
buffer_store_dwordx4 v[60:63], v22, s[4:7], s32 offen sc1
I_S2:
s_cmp_lg_u32 s16, 0
s_cbranch_scc1 PRP_10
s_add_u32 s24, s22, 18432
POLL_12:
buffer_load_dword v111, off, s[4:7], s24 sc1
s_waitcnt vmcnt(0)
v_readfirstlane_b32 s23, v111
s_nop 0
s_cmp_ge_u32 s23, 16
s_cbranch_scc1 PX_13
s_sub_u32 s21, s21, 1
s_cbranch_scc1 PX_13_t
s_sleep 2
s_branch POLL_12
PX_13_t:
s_mov_b32 s21, 0
PX_13:
PRP_10:
s_barrier
s_mov_b32 s47, s40
s_mov_b32 s55, 0
s_lshl_b32 s56, s16, 11
s_mul_i32 s57, s15, 98304
s_add_u32 s57, s57, 1048576
s_lshl_b32 s58, s16, 12
s_mov_b32 s59, s57
s_add_u32 s57, s57, s56
s_add_u32 s23, s14, 0
s_and_b32 s23, s23, 3
s_lshl_b32 s23, s23, 13
s_add_u32 s23, s23, s57
s_add_u32 m0, s56, 32768
s_add_u32 s24, s23, 32768
buffer_load_dwordx4 v1, s[4:7], s24 offen offset:0 sc1 lds
buffer_load_dwordx4 v1, s[4:7], s24 offen offset:1024 sc1 lds
s_add_u32 m0, s56, 65536
s_add_u32 s24, s23, 65536
buffer_load_dwordx4 v1, s[4:7], s24 offen offset:0 sc1 lds
buffer_load_dwordx4 v1, s[4:7], s24 offen offset:1024 sc1 lds
s_add_u32 s23, s14, 1
s_and_b32 s23, s23, 3
s_lshl_b32 s23, s23, 13
s_add_u32 s23, s23, s57
s_add_u32 m0, s56, 40960
s_add_u32 s24, s23, 32768
buffer_load_dwordx4 v1, s[4:7], s24 offen offset:0 sc1 lds
buffer_load_dwordx4 v1, s[4:7], s24 offen offset:1024 sc1 lds
s_add_u32 m0, s56, 73728
s_add_u32 s24, s23, 65536
buffer_load_dwordx4 v1, s[4:7], s24 offen offset:0 sc1 lds
buffer_load_dwordx4 v1, s[4:7], s24 offen offset:1024 sc1 lds
s_branch K1GO
LAYER:
s_lshr_b32 s24, s16, 1
s_lshl_b32 s24, s24, 11
s_add_u32 s24, s24, s22
s_sub_u32 s24, s24, 20480
s_lshr_b32 s23, s16, 1
s_add_u32 s23, s23, 6
POLL_14:
s_mov_b64 exec, 0xffff
buffer_load_dword v111, v1, s[4:7], s3 offen sc1
s_mov_b64 exec, -1
s_waitcnt vmcnt(0)
v_cmp_gt_u32 s[96:97], s23, v111
s_nop 0
s_and_b32 s96, s96, 0xffff
s_cbranch_scc0 PX_15
s_sub_u32 s21, s21, 1
s_cbranch_scc1 PX_15_t
s_and_b32 s96, s21, 15
s_cbranch_scc1 POLL_14
buffer_load_dword v111, off, s[4:7], s24 sc1
s_waitcnt vmcnt(0)
v_readfirstlane_b32 s96, v111
s_nop 0
s_cmp_lt_u32 s96, 16
s_cbranch_scc1 POLL_14
s_branch PX_15
PX_15_t:
s_mov_b32 s21, 0
PX_15:
K1GO:
s_lshl_b32 s30, s16, 15
s_add_u32 s30, s30, s41
s_add_u32 s30, s30, s20
s_add_u32 s24, s30, 16777216
s_add_u32 s30, s14, 0
s_and_b32 s30, s30, 3
s_lshl_b32 s30, s30, 12
s_add_u32 s30, s30, s24
s_add_u32 s31, s14, 1
s_and_b32 s31, s31, 3
s_lshl_b32 s31, s31, 12
s_add_u32 s31, s31, s24
s_add_u32 s32, s14, 2
s_and_b32 s32, s32, 3
s_lshl_b32 s32, s32, 12
s_add_u32 s32, s32, s24
s_add_u32 s33, s14, 3
s_and_b32 s33, s33, 3
s_lshl_b32 s33, s33, 12
s_add_u32 s33, s33, s24
buffer_load_dwordx4 v[128:131], v2, s[4:7], s30 offen offset:0 sc1
buffer_load_dwordx4 v[132:135], v2, s[4:7], s30 offen offset:512 sc1
buffer_load_dwordx4 v[136:139], v2, s[4:7], s30 offen offset:1024 sc1
buffer_load_dwordx4 v[140:143], v2, s[4:7], s30 offen offset:1536 sc1
buffer_load_dwordx4 v[144:147], v2, s[4:7], s30 offen offset:2048 sc1
buffer_load_dwordx4 v[148:151], v2, s[4:7], s30 offen offset:2560 sc1
buffer_load_dwordx4 v[152:155], v2, s[4:7], s30 offen offset:3072 sc1
buffer_load_dwordx4 v[156:159], v2, s[4:7], s30 offen offset:3584 sc1
buffer_load_dwordx4 v[160:163], v2, s[4:7], s31 offen offset:0 sc1
buffer_load_dwordx4 v[164:167], v2, s[4:7], s31 offen offset:512 sc1
v_add_u32 v110, 0x10000, v1
s_cmp_lg_u32 s18, 0
s_cbranch_scc1 K1CS_16
s_add_u32 s24, s56, 32768
v_add_u32 v120, s24, v1
v_add_u32 v121, s58, v1
v_accvgpr_write_b32 a80, s46
v_accvgpr_write_b32 a81, s46
v_accvgpr_write_b32 a82, s46
v_accvgpr_write_b32 a83, s46
s_add_u32 s23, s14, 2
s_and_b32 s23, s23, 3
s_lshl_b32 s23, s23, 13
s_add_u32 s23, s23, s57
s_add_u32 m0, s56, 49152
s_add_u32 s24, s23, 32768
buffer_load_dwordx4 v1, s[4:7], s24 offen offset:0 sc1 lds
buffer_load_dwordx4 v1, s[4:7], s24 offen offset:1024 sc1 lds
s_add_u32 m0, s56, 81920
s_add_u32 s24, s23, 65536
buffer_load_dwordx4 v1, s[4:7], s24 offen offset:0 sc1 lds
buffer_load_dwordx4 v1, s[4:7], s24 offen offset:1024 sc1 lds
s_waitcnt vmcnt(18)
ds_read_b128 a[64:67], v120 offset:0
ds_read_b128 a[68:71], v120 offset:1024
ds_read_b128 a[72:75], v120 offset:32768
ds_read_b128 a[76:79], v120 offset:33792
s_waitcnt lgkmcnt(0)
v_mfma_f32_32x32x16_bf16 a[16:31], a[80:83], a[64:67], 0
v_mfma_f32_32x32x16_bf16 a[16:31], a[80:83], a[68:71], a[16:31]
v_mfma_f32_32x32x16_bf16 a[32:47], a[80:83], a[72:75], 0
v_mfma_f32_32x32x16_bf16 a[32:47], a[80:83], a[76:79], a[32:47]
s_barrier
K1CS_16:
v_and_b32 v104, 31, v0
v_lshlrev_b32 v104, 3, v104
v_lshrrev_b32 v105, 5, v0
v_lshl_add_u32 v104, v105, 10, v104
s_lshl_b32 s24, s14, 13
s_lshl_b32 s25, s16, 11
s_add_u32 s24, s24, s25
s_add_u32 s24, s24, s20
s_add_u32 s34, s24, 18874368
buffer_load_dwordx2 v[112:113], v104, s[4:7], s34 offen offset:0 sc1
buffer_load_dwordx2 v[114:115], v104, s[4:7], s34 offen offset:256 sc1
buffer_load_dwordx2 v[116:117], v104, s[4:7], s34 offen offset:512 sc1
buffer_load_dwordx2 v[118:119], v104, s[4:7], s34 offen offset:768 sc1
ds_read_b128 v[72:75], v1 offset:32768
ds_read_b128 v[76:79], v110 offset:0
ds_read_b128 v[80:83], v1 offset:33792
ds_read_b128 v[84:87], v110 offset:1024
ds_read_b128 v[88:91], v1 offset:34816
ds_read_b128 v[92:95], v110 offset:2048
s_waitcnt vmcnt(13)
s_waitcnt lgkmcnt(4)
v_mfma_f32_32x32x16_bf16 v[24:39], v[72:75], v[128:131], 0
ds_read_b128 v[96:99], v1 offset:35840
buffer_load_dwordx4 v[168:171], v2, s[4:7], s31 offen offset:1024 sc1
v_mfma_f32_32x32x16_bf16 v[40:55], v[128:131], v[76:79], 0
ds_read_b128 v[100:103], v110 offset:3072
s_waitcnt vmcnt(13)
s_waitcnt lgkmcnt(4)
v_mfma_f32_32x32x16_bf16 v[24:39], v[80:83], v[132:135], v[24:39]
ds_read_b128 v[72:75], v1 offset:36864
buffer_load_dwordx4 v[172:175], v2, s[4:7], s31 offen offset:1536 sc1
v_mfma_f32_32x32x16_bf16 v[40:55], v[132:135], v[84:87], v[40:55]
ds_read_b128 v[76:79], v110 offset:4096
s_waitcnt vmcnt(13)
s_waitcnt lgkmcnt(4)
v_mfma_f32_32x32x16_bf16 v[24:39], v[88:91], v[136:139], v[24:39]
ds_read_b128 v[80:83], v1 offset:37888
buffer_load_dwordx4 v[176:179], v2, s[4:7], s31 offen offset:2048 sc1
v_mfma_f32_32x32x16_bf16 v[40:55], v[136:139], v[92:95], v[40:55]
ds_read_b128 v[84:87], v110 offset:5120
s_waitcnt vmcnt(13)
s_waitcnt lgkmcnt(4)
v_mfma_f32_32x32x16_bf16 v[24:39], v[96:99], v[140:143], v[24:39]
ds_read_b128 v[88:91], v1 offset:38912
buffer_load_dwordx4 v[180:183], v2, s[4:7], s31 offen offset:2560 sc1
v_mfma_f32_32x32x16_bf16 v[40:55], v[140:143], v[100:103], v[40:55]
ds_read_b128 v[92:95], v110 offset:6144
s_waitcnt vmcnt(13)
s_waitcnt lgkmcnt(4)
v_mfma_f32_32x32x16_bf16 v[24:39], v[72:75], v[144:147], v[24:39]
ds_read_b128 v[96:99], v1 offset:39936
buffer_load_dwordx4 v[184:187], v2, s[4:7], s31 offen offset:3072 sc1
v_mfma_f32_32x32x16_bf16 v[40:55], v[144:147], v[76:79], v[40:55]
ds_read_b128 v[100:103], v110 offset:7168
s_cmp_eq_u32 s18, 0
s_cbranch_scc1 WS_18_s
WS_18:
s_waitcnt vmcnt(13)
s_waitcnt lgkmcnt(4)
v_mfma_f32_32x32x16_bf16 v[24:39], v[80:83], v[148:151], v[24:39]
ds_read_b128 v[72:75], v1 offset:40960
buffer_load_dwordx4 v[188:191], v2, s[4:7], s31 offen offset:3584 sc1
v_mfma_f32_32x32x16_bf16 v[40:55], v[148:151], v[84:87], v[40:55]
ds_read_b128 v[76:79], v110 offset:8192
s_waitcnt vmcnt(13)
s_waitcnt lgkmcnt(4)
v_mfma_f32_32x32x16_bf16 v[24:39], v[88:91], v[152:155], v[24:39]
ds_read_b128 v[80:83], v1 offset:41984
buffer_load_dwordx4 v[192:195], v2, s[4:7], s32 offen offset:0 sc1
v_mfma_f32_32x32x16_bf16 v[40:55], v[152:155], v[92:95], v[40:55]
ds_read_b128 v[84:87], v110 offset:9216
s_waitcnt vmcnt(13)
s_waitcnt lgkmcnt(4)
v_mfma_f32_32x32x16_bf16 v[24:39], v[96:99], v[156:159], v[24:39]
ds_read_b128 v[88:91], v1 offset:43008
buffer_load_dwordx4 v[196:199], v2, s[4:7], s32 offen offset:512 sc1
v_mfma_f32_32x32x16_bf16 v[40:55], v[156:159], v[100:103], v[40:55]
ds_read_b128 v[92:95], v110 offset:10240
s_waitcnt vmcnt(13)
s_waitcnt lgkmcnt(4)
v_mfma_f32_32x32x16_bf16 v[24:39], v[72:75], v[160:163], v[24:39]
ds_read_b128 v[96:99], v1 offset:44032
buffer_load_dwordx4 v[200:203], v2, s[4:7], s32 offen offset:1024 sc1
v_mfma_f32_32x32x16_bf16 v[40:55], v[160:163], v[76:79], v[40:55]
ds_read_b128 v[100:103], v110 offset:11264
s_waitcnt vmcnt(13)
s_waitcnt lgkmcnt(4)
v_mfma_f32_32x32x16_bf16 v[24:39], v[80:83], v[164:167], v[24:39]
ds_read_b128 v[72:75], v1 offset:45056
buffer_load_dwordx4 v[204:207], v2, s[4:7], s32 offen offset:1536 sc1
v_mfma_f32_32x32x16_bf16 v[40:55], v[164:167], v[84:87], v[40:55]
ds_read_b128 v[76:79], v110 offset:12288
s_waitcnt vmcnt(9)
s_waitcnt lgkmcnt(4)
v_mfma_f32_32x32x16_bf16 v[24:39], v[88:91], v[168:171], v[24:39]
ds_read_b128 v[80:83], v1 offset:46080
buffer_load_dwordx4 v[208:211], v2, s[4:7], s32 offen offset:2048 sc1
v_mfma_f32_32x32x16_bf16 v[40:55], v[168:171], v[92:95], v[40:55]
ds_read_b128 v[84:87], v110 offset:13312
s_waitcnt vmcnt(9)
s_waitcnt lgkmcnt(4)
v_mfma_f32_32x32x16_bf16 v[24:39], v[96:99], v[172:175], v[24:39]
ds_read_b128 v[88:91], v1 offset:47104
buffer_load_dwordx4 v[212:215], v2, s[4:7], s32 offen offset:2560 sc1
v_mfma_f32_32x32x16_bf16 v[40:55], v[172:175], v[100:103], v[40:55]
ds_read_b128 v[92:95], v110 offset:14336
s_waitcnt vmcnt(9)
s_waitcnt lgkmcnt(4)
v_mfma_f32_32x32x16_bf16 v[24:39], v[72:75], v[176:179], v[24:39]
ds_read_b128 v[96:99], v1 offset:48128
buffer_load_dwordx4 v[216:219], v2, s[4:7], s32 offen offset:3072 sc1
s_waitcnt vmcnt(13)
v_add_f32 v104, v112, v114
v_add_f32 v106, v113, v115
v_mfma_f32_32x32x16_bf16 v[40:55], v[176:179], v[76:79], v[40:55]
ds_read_b128 v[100:103], v110 offset:15360
s_cmp_eq_u32 s18, 0
s_cbranch_scc1 WS_19_s
WS_19:
s_waitcnt vmcnt(9)
s_waitcnt lgkmcnt(4)
v_mfma_f32_32x32x16_bf16 v[24:39], v[80:83], v[180:183], v[24:39]
ds_read_b128 v[72:75], v1 offset:49152
buffer_load_dwordx4 v[220:223], v2, s[4:7], s32 offen offset:3584 sc1
v_add_f32 v105, v116, v118
v_add_f32 v107, v117, v119
v_add_f32 v104, v104, v105
v_mfma_f32_32x32x16_bf16 v[40:55], v[180:183], v[84:87], v[40:55]
ds_read_b128 v[76:79], v110 offset:16384
s_waitcnt vmcnt(9)
s_waitcnt lgkmcnt(4)
v_mfma_f32_32x32x16_bf16 v[24:39], v[88:91], v[184:187], v[24:39]
ds_read_b128 v[80:83], v1 offset:50176
buffer_load_dwordx4 v[224:227], v2, s[4:7], s33 offen offset:0 sc1
v_add_f32 v106, v106, v107
v_lshrrev_b32 v21, 5, v0
v_mov_b32 v105, v104
v_mfma_f32_32x32x16_bf16 v[40:55], v[184:187], v[92:95], v[40:55]
ds_read_b128 v[84:87], v110 offset:17408
s_waitcnt vmcnt(9)
s_waitcnt lgkmcnt(4)
v_mfma_f32_32x32x16_bf16 v[24:39], v[96:99], v[188:191], v[24:39]
ds_read_b128 v[88:91], v1 offset:51200
buffer_load_dwordx4 v[228:231], v2, s[4:7], s33 offen offset:512 sc1
v_mov_b32 v107, v106
v_lshlrev_b32 v21, 4, v21
v_add_u32 v21, 147456, v21
v_mfma_f32_32x32x16_bf16 v[40:55], v[188:191], v[100:103], v[40:55]
ds_read_b128 v[92:95], v110 offset:18432
s_waitcnt vmcnt(9)
s_waitcnt lgkmcnt(4)
v_mfma_f32_32x32x16_bf16 v[24:39], v[72:75], v[192:195], v[24:39]
ds_read_b128 v[96:99], v1 offset:52224
buffer_load_dwordx4 v[232:235], v2, s[4:7], s33 offen offset:1024 sc1
v_permlane32_swap_b32 v104, v105
v_permlane32_swap_b32 v106, v107
v_add_f32 v104, v104, v105
v_mfma_f32_32x32x16_bf16 v[40:55], v[192:195], v[76:79], v[40:55]
ds_read_b128 v[100:103], v110 offset:19456
s_waitcnt vmcnt(9)
s_waitcnt lgkmcnt(4)
v_mfma_f32_32x32x16_bf16 v[24:39], v[80:83], v[196:199], v[24:39]
ds_read_b128 v[72:75], v1 offset:53248
buffer_load_dwordx4 v[236:239], v2, s[4:7], s33 offen offset:1536 sc1
v_add_f32 v106, v106, v107
v_mul_f32 v108, 0x3b000000, v104
v_mul_f32 v106, 0x3b000000, v106
v_mfma_f32_32x32x16_bf16 v[40:55], v[196:199], v[84:87], v[40:55]
ds_read_b128 v[76:79], v110 offset:20480
s_waitcnt vmcnt(9)
s_waitcnt lgkmcnt(4)
v_mfma_f32_32x32x16_bf16 v[24:39], v[88:91], v[200:203], v[24:39]
ds_read_b128 v[80:83], v1 offset:54272
buffer_load_dwordx4 v[240:243], v2, s[4:7], s33 offen offset:2048 sc1
v_fma_f32 v106, -v108, v108, v106
v_max_f32 v106, 0, v106
v_add_f32 v106, 0x3727c5ac, v106
v_mfma_f32_32x32x16_bf16 v[40:55], v[200:203], v[92:95], v[40:55]
ds_read_b128 v[84:87], v110 offset:21504
s_waitcnt vmcnt(9)
s_waitcnt lgkmcnt(4)
v_mfma_f32_32x32x16_bf16 v[24:39], v[96:99], v[204:207], v[24:39]
ds_read_b128 v[88:91], v1 offset:55296
buffer_load_dwordx4 v[244:247], v2, s[4:7], s33 offen offset:2560 sc1
v_rsq_f32 v106, v106
v_and_b32 v20, 31, v0
v_lshlrev_b32 v20, 2, v20
v_mfma_f32_32x32x16_bf16 v[40:55], v[204:207], v[100:103], v[40:55]
ds_read_b128 v[92:95], v110 offset:22528
s_waitcnt vmcnt(9)
s_waitcnt lgkmcnt(4)
v_mfma_f32_32x32x16_bf16 v[24:39], v[72:75], v[208:211], v[24:39]
ds_read_b128 v[96:99], v1 offset:56320
buffer_load_dwordx4 v[248:251], v2, s[4:7], s33 offen offset:3072 sc1
s_lshl_b32 s26, s16, 8
s_add_u32 s26, s26, 149504
v_add_u32 v22, s26, v20
v_add_u32 v20, 147712, v20
ds_write_b32 v22, v108
v_mfma_f32_32x32x16_bf16 v[40:55], v[208:211], v[76:79], v[40:55]
ds_read_b128 v[100:103], v110 offset:23552
s_cmp_eq_u32 s18, 0
s_cbranch_scc1 WS_20_s
WS_20:
s_waitcnt vmcnt(9)
s_waitcnt lgkmcnt(5)
v_mfma_f32_32x32x16_bf16 v[24:39], v[80:83], v[212:215], v[24:39]
ds_read_b128 v[72:75], v1 offset:57344
buffer_load_dwordx4 v[252:255], v2, s[4:7], s33 offen offset:3584 sc1
ds_write_b32 v22, v106 offset:128
s_sub_u32 s26, s26, 147456
v_add_u32 v22, s26, v21
v_mfma_f32_32x32x16_bf16 v[40:55], v[212:215], v[84:87], v[40:55]
ds_read_b128 v[76:79], v110 offset:24576
s_waitcnt vmcnt(9)
s_waitcnt lgkmcnt(6)
v_mfma_f32_32x32x16_bf16 v[24:39], v[88:91], v[216:219], v[24:39]
ds_read_b128 v[80:83], v1 offset:58368
ds_read_b128 v[56:59], v22 offset:0
ds_read_b128 v[60:63], v22 offset:32
ds_read_b128 v[64:67], v22 offset:64
v_mfma_f32_32x32x16_bf16 v[40:55], v[216:219], v[92:95], v[40:55]
ds_read_b128 v[84:87], v110 offset:25600
s_waitcnt vmcnt(8)
s_waitcnt lgkmcnt(8)
v_mfma_f32_32x32x16_bf16 v[24:39], v[96:99], v[220:223], v[24:39]
ds_read_b128 v[88:91], v1 offset:59392
ds_read_b128 v[68:71], v22 offset:96
ds_read_b128 v[4:7], v22 offset:128
ds_read_b128 v[8:11], v22 offset:160
v_mfma_f32_32x32x16_bf16 v[40:55], v[220:223], v[100:103], v[40:55]
ds_read_b128 v[92:95], v110 offset:26624
s_waitcnt vmcnt(7)
s_waitcnt lgkmcnt(10)
v_mfma_f32_32x32x16_bf16 v[24:39], v[72:75], v[224:227], v[24:39]
ds_read_b128 v[96:99], v1 offset:60416
ds_read_b128 v[12:15], v22 offset:192
ds_read_b128 v[16:19], v22 offset:224
s_lshl_b32 s26, s16, 12
v_mfma_f32_32x32x16_bf16 v[40:55], v[224:227], v[76:79], v[40:55]
ds_read_b128 v[100:103], v110 offset:27648
s_waitcnt vmcnt(6)
s_waitcnt lgkmcnt(9)
v_mfma_f32_32x32x16_bf16 v[24:39], v[80:83], v[228:231], v[24:39]
ds_read_b128 v[72:75], v1 offset:61440
s_add_u32 s25, s26, 131072
v_add_u32 v23, s25, v1
s_lshl_b32 s25, s14, 4
v_mfma_f32_32x32x16_bf16 v[40:55], v[228:231], v[84:87], v[40:55]
ds_read_b128 v[76:79], v110 offset:28672
s_waitcnt vmcnt(5)
s_waitcnt lgkmcnt(6)
v_mfma_f32_32x32x16_bf16 v[24:39], v[88:91], v[232:235], v[24:39]
ds_read_b128 v[80:83], v1 offset:62464
s_add_u32 s25, s25, s15
s_lshl_b32 s25, s25, 14
s_add_u32 s25, s25, s26
v_mfma_f32_32x32x16_bf16 v[40:55], v[232:235], v[92:95], v[40:55]
ds_read_b128 v[84:87], v110 offset:29696
s_waitcnt vmcnt(4)
s_waitcnt lgkmcnt(4)
v_mfma_f32_32x32x16_bf16 v[24:39], v[96:99], v[236:239], v[24:39]
ds_read_b128 v[88:91], v1 offset:63488
s_add_u32 s25, s25, s17
v_mfma_f32_32x32x16_bf16 v[40:55], v[236:239], v[100:103], v[40:55]
ds_read_b128 v[92:95], v110 offset:30720
s_waitcnt vmcnt(3)
s_waitcnt lgkmcnt(4)
v_mfma_f32_32x32x16_bf16 v[24:39], v[72:75], v[240:243], v[24:39]
ds_read_b128 v[96:99], v1 offset:64512
v_mfma_f32_32x32x16_bf16 v[40:55], v[240:243], v[76:79], v[40:55]
ds_read_b128 v[100:103], v110 offset:31744
s_cmp_eq_u32 s18, 0
s_cbranch_scc1 WS_21_s
WS_21:
s_waitcnt vmcnt(2)
s_waitcnt lgkmcnt(4)
v_mfma_f32_32x32x16_bf16 v[24:39], v[80:83], v[244:247], v[24:39]
ds_read_b128 v[72:75], v1 offset:0
v_mfma_f32_32x32x16_bf16 v[40:55], v[244:247], v[84:87], v[40:55]
s_waitcnt vmcnt(1)
s_waitcnt lgkmcnt(3)
v_mfma_f32_32x32x16_bf16 v[24:39], v[88:91], v[248:251], v[24:39]
ds_read_b128 v[80:83], v1 offset:1024
ds_read_b128 v[112:115], v21 offset:128
ds_read_b128 v[116:119], v21 offset:160
ds_read_b128 v[120:123], v21 offset:192
ds_read_b128 v[124:127], v21 offset:224
ds_read_b32 v104, v20
v_mfma_f32_32x32x16_bf16 v[40:55], v[248:251], v[92:95], v[40:55]
s_waitcnt vmcnt(0)
s_waitcnt lgkmcnt(7)
v_mfma_f32_32x32x16_bf16 v[24:39], v[96:99], v[252:255], v[24:39]
ds_read_b128 v[88:91], v1 offset:2048
v_mfma_f32_32x32x16_bf16 v[40:55], v[252:255], v[100:103], v[40:55]
s_waitcnt lgkmcnt(1)
s_nop 8
v_pk_fma_f32 v[24:25], v[108:109], v[112:113], v[24:25] op_sel_hi:[0,1,1] neg_lo:[1,0,0] neg_hi:[1,0,0]
v_pk_fma_f32 v[26:27], v[108:109], v[114:115], v[26:27] op_sel_hi:[0,1,1] neg_lo:[1,0,0] neg_hi:[1,0,0]
v_pk_fma_f32 v[28:29], v[108:109], v[116:117], v[28:29] op_sel_hi:[0,1,1] neg_lo:[1,0,0] neg_hi:[1,0,0]
v_pk_fma_f32 v[30:31], v[108:109], v[118:119], v[30:31] op_sel_hi:[0,1,1] neg_lo:[1,0,0] neg_hi:[1,0,0]
v_pk_fma_f32 v[32:33], v[108:109], v[120:121], v[32:33] op_sel_hi:[0,1,1] neg_lo:[1,0,0] neg_hi:[1,0,0]
v_pk_fma_f32 v[34:35], v[108:109], v[122:123], v[34:35] op_sel_hi:[0,1,1] neg_lo:[1,0,0] neg_hi:[1,0,0]
v_pk_fma_f32 v[36:37], v[108:109], v[124:125], v[36:37] op_sel_hi:[0,1,1] neg_lo:[1,0,0] neg_hi:[1,0,0]
v_pk_fma_f32 v[38:39], v[108:109], v[126:127], v[38:39] op_sel_hi:[0,1,1] neg_lo:[1,0,0] neg_hi:[1,0,0]
ds_read_b128 v[112:115], v21 offset:0
ds_read_b128 v[116:119], v21 offset:32
ds_read_b128 v[120:123], v21 offset:64
ds_read_b128 v[124:127], v21 offset:96
v_pk_mul_f32 v[24:25], v[106:107], v[24:25] op_sel_hi:[0,1]
v_pk_mul_f32 v[26:27], v[106:107], v[26:27] op_sel_hi:[0,1]
v_pk_mul_f32 v[28:29], v[106:107], v[28:29] op_sel_hi:[0,1]
v_pk_mul_f32 v[30:31], v[106:107], v[30:31] op_sel_hi:[0,1]
v_pk_mul_f32 v[32:33], v[106:107], v[32:33] op_sel_hi:[0,1]
v_pk_mul_f32 v[34:35], v[106:107], v[34:35] op_sel_hi:[0,1]
v_pk_mul_f32 v[36:37], v[106:107], v[36:37] op_sel_hi:[0,1]
v_pk_mul_f32 v[38:39], v[106:107], v[38:39] op_sel_hi:[0,1]
v_cvt_pk_bf16_f32 v24, v24, v25
v_cvt_pk_bf16_f32 v25, v26, v27
v_cvt_pk_bf16_f32 v26, v28, v29
v_cvt_pk_bf16_f32 v27, v30, v31
v_cvt_pk_bf16_f32 v28, v32, v33
v_cvt_pk_bf16_f32 v29, v34, v35
v_cvt_pk_bf16_f32 v30, v36, v37
v_cvt_pk_bf16_f32 v31, v38, v39
buffer_store_dwordx4 v[24:27], v1, s[4:7], s25 offen sc1
buffer_store_dwordx4 v[28:31], v1, s[4:7], s25 offen offset:1024 sc1
v_pk_fma_f32 v[40:41], v[104:105], v[56:57], v[40:41] op_sel_hi:[0,1,1] neg_lo:[1,0,0] neg_hi:[1,0,0]
v_pk_fma_f32 v[42:43], v[104:105], v[58:59], v[42:43] op_sel_hi:[0,1,1] neg_lo:[1,0,0] neg_hi:[1,0,0]
v_pk_fma_f32 v[44:45], v[104:105], v[60:61], v[44:45] op_sel_hi:[0,1,1] neg_lo:[1,0,0] neg_hi:[1,0,0]
v_pk_fma_f32 v[46:47], v[104:105], v[62:63], v[46:47] op_sel_hi:[0,1,1] neg_lo:[1,0,0] neg_hi:[1,0,0]
v_pk_fma_f32 v[48:49], v[104:105], v[64:65], v[48:49] op_sel_hi:[0,1,1] neg_lo:[1,0,0] neg_hi:[1,0,0]
v_pk_fma_f32 v[50:51], v[104:105], v[66:67], v[50:51] op_sel_hi:[0,1,1] neg_lo:[1,0,0] neg_hi:[1,0,0]
v_pk_fma_f32 v[52:53], v[104:105], v[68:69], v[52:53] op_sel_hi:[0,1,1] neg_lo:[1,0,0] neg_hi:[1,0,0]
v_pk_fma_f32 v[54:55], v[104:105], v[70:71], v[54:55] op_sel_hi:[0,1,1] neg_lo:[1,0,0] neg_hi:[1,0,0]
v_pk_mul_f32 v[40:41], v[4:5], v[40:41]
v_pk_mul_f32 v[42:43], v[6:7], v[42:43]
v_pk_mul_f32 v[44:45], v[8:9], v[44:45]
v_pk_mul_f32 v[46:47], v[10:11], v[46:47]
v_pk_mul_f32 v[48:49], v[12:13], v[48:49]
v_pk_mul_f32 v[50:51], v[14:15], v[50:51]
v_pk_mul_f32 v[52:53], v[16:17], v[52:53]
v_pk_mul_f32 v[54:55], v[18:19], v[54:55]
v_cvt_pk_bf16_f32 v40, v40, v41
v_cvt_pk_bf16_f32 v41, v42, v43
v_cvt_pk_bf16_f32 v42, v44, v45
v_cvt_pk_bf16_f32 v43, v46, v47
v_cvt_pk_bf16_f32 v44, v48, v49
v_cvt_pk_bf16_f32 v45, v50, v51
v_cvt_pk_bf16_f32 v46, v52, v53
v_cvt_pk_bf16_f32 v47, v54, v55
buffer_store_dwordx4 v[40:43], v1, s[4:7], s25 offen offset:2048 sc1
buffer_store_dwordx4 v[44:47], v1, s[4:7], s25 offen offset:3072 sc1
s_and_b32 s35, s15, 3
s_lshl_b32 s35, s35, 2
s_add_u32 s35, s35, s16
s_lshl_b32 s35, s35, 15
s_add_u32 s35, s35, 2621440
s_waitcnt lgkmcnt(11)
v_mfma_f32_32x32x16_bf16 v[56:71], v[72:75], v[128:131], 0
ds_write_b128 v23, v[24:27]
ds_read_b128 v[96:99], v1 offset:3072
s_waitcnt lgkmcnt(12)
v_mfma_f32_32x32x16_bf16 v[56:71], v[80:83], v[132:135], v[56:71]
ds_write_b128 v23, v[28:31] offset:1024
ds_read_b128 v[72:75], v1 offset:4096
s_waitcnt lgkmcnt(8)
v_mfma_f32_32x32x16_bf16 v[56:71], v[88:91], v[136:139], v[56:71]
ds_write_b128 v23, v[40:43] offset:2048
ds_read_b128 v[80:83], v1 offset:5120
s_waitcnt lgkmcnt(4)
v_mfma_f32_32x32x16_bf16 v[56:71], v[96:99], v[140:143], v[56:71]
ds_write_b128 v23, v[44:47] offset:3072
ds_read_b128 v[88:91], v1 offset:6144
s_waitcnt lgkmcnt(4)
v_mfma_f32_32x32x16_bf16 v[56:71], v[72:75], v[144:147], v[56:71]
v_mul_f32 v106, 0x3eb8aa3b, v106
ds_read_b128 v[96:99], v1 offset:7168
s_waitcnt lgkmcnt(3)
v_mfma_f32_32x32x16_bf16 v[56:71], v[80:83], v[148:151], v[56:71]
s_nop 0
ds_read_b128 v[72:75], v1 offset:8192
s_waitcnt lgkmcnt(2)
v_mfma_f32_32x32x16_bf16 v[56:71], v[88:91], v[152:155], v[56:71]
s_nop 0
ds_read_b128 v[80:83], v1 offset:9216
s_waitcnt lgkmcnt(2)
v_mfma_f32_32x32x16_bf16 v[56:71], v[96:99], v[156:159], v[56:71]
s_nop 0
ds_read_b128 v[88:91], v1 offset:10240
s_waitcnt lgkmcnt(2)
v_mfma_f32_32x32x16_bf16 v[56:71], v[72:75], v[160:163], v[56:71]
s_nop 0
ds_read_b128 v[96:99], v1 offset:11264
s_waitcnt lgkmcnt(2)
v_mfma_f32_32x32x16_bf16 v[56:71], v[80:83], v[164:167], v[56:71]
s_nop 0
ds_read_b128 v[72:75], v1 offset:12288
s_waitcnt lgkmcnt(2)
v_mfma_f32_32x32x16_bf16 v[56:71], v[88:91], v[168:171], v[56:71]
s_nop 0
ds_read_b128 v[80:83], v1 offset:13312
s_waitcnt lgkmcnt(2)
v_mfma_f32_32x32x16_bf16 v[56:71], v[96:99], v[172:175], v[56:71]
s_nop 0
ds_read_b128 v[88:91], v1 offset:14336
s_waitcnt lgkmcnt(2)
v_mfma_f32_32x32x16_bf16 v[56:71], v[72:75], v[176:179], v[56:71]
s_nop 0
ds_read_b128 v[96:99], v1 offset:15360
s_waitcnt lgkmcnt(2)
v_mfma_f32_32x32x16_bf16 v[56:71], v[80:83], v[180:183], v[56:71]
s_nop 0
ds_read_b128 v[72:75], v1 offset:16384
s_waitcnt lgkmcnt(2)
v_mfma_f32_32x32x16_bf16 v[56:71], v[88:91], v[184:187], v[56:71]
s_nop 0
ds_read_b128 v[80:83], v1 offset:17408
s_waitcnt lgkmcnt(2)
v_mfma_f32_32x32x16_bf16 v[56:71], v[96:99], v[188:191], v[56:71]
s_nop 0
ds_read_b128 v[88:91], v1 offset:18432
s_waitcnt lgkmcnt(2)
v_mfma_f32_32x32x16_bf16 v[56:71], v[72:75], v[192:195], v[56:71]
s_nop 0
ds_read_b128 v[96:99], v1 offset:19456
s_waitcnt lgkmcnt(2)
v_mfma_f32_32x32x16_bf16 v[56:71], v[80:83], v[196:199], v[56:71]
s_nop 0
ds_read_b128 v[72:75], v1 offset:20480
s_waitcnt lgkmcnt(2)
v_mfma_f32_32x32x16_bf16 v[56:71], v[88:91], v[200:203], v[56:71]
s_nop 0
ds_read_b128 v[80:83], v1 offset:21504
s_waitcnt lgkmcnt(2)
v_mfma_f32_32x32x16_bf16 v[56:71], v[96:99], v[204:207], v[56:71]
s_nop 0
ds_read_b128 v[88:91], v1 offset:22528
s_waitcnt lgkmcnt(2)
v_mfma_f32_32x32x16_bf16 v[56:71], v[72:75], v[208:211], v[56:71]
s_nop 0
ds_read_b128 v[96:99], v1 offset:23552
s_waitcnt lgkmcnt(2)
v_mfma_f32_32x32x16_bf16 v[56:71], v[80:83], v[212:215], v[56:71]
s_nop 0
ds_read_b128 v[72:75], v1 offset:24576
s_waitcnt lgkmcnt(2)
v_mfma_f32_32x32x16_bf16 v[56:71], v[88:91], v[216:219], v[56:71]
s_nop 0
ds_read_b128 v[80:83], v1 offset:25600
s_waitcnt lgkmcnt(2)
v_mfma_f32_32x32x16_bf16 v[56:71], v[96:99], v[220:223], v[56:71]
s_nop 0
ds_read_b128 v[88:91], v1 offset:26624
s_waitcnt lgkmcnt(2)
v_mfma_f32_32x32x16_bf16 v[56:71], v[72:75], v[224:227], v[56:71]
s_waitcnt vmcnt(0)
s_mov_b64 exec, 1
v_mov_b32 v111, 1
buffer_atomic_add v111, off, s[4:7], s28
s_mov_b64 exec, -1
ds_read_b128 v[96:99], v1 offset:27648
s_waitcnt lgkmcnt(2)
v_mfma_f32_32x32x16_bf16 v[56:71], v[80:83], v[228:231], v[56:71]
buffer_load_dword v111, v1, s[4:7], s25 offen offset:0 sc1
ds_read_b128 v[72:75], v1 offset:28672
s_waitcnt lgkmcnt(2)
v_mfma_f32_32x32x16_bf16 v[56:71], v[88:91], v[232:235], v[56:71]
buffer_load_dword v111, v1, s[4:7], s25 offen offset:1024 sc1
ds_read_b128 v[80:83], v1 offset:29696
s_waitcnt lgkmcnt(2)
v_mfma_f32_32x32x16_bf16 v[56:71], v[96:99], v[236:239], v[56:71]
buffer_load_dword v111, v1, s[4:7], s25 offen offset:2048 sc1
ds_read_b128 v[88:91], v1 offset:30720
s_waitcnt lgkmcnt(2)
v_mfma_f32_32x32x16_bf16 v[56:71], v[72:75], v[240:243], v[56:71]
buffer_load_dword v111, v1, s[4:7], s25 offen offset:3072 sc1
ds_read_b128 v[96:99], v1 offset:31744
s_waitcnt lgkmcnt(2)
v_mfma_f32_32x32x16_bf16 v[56:71], v[80:83], v[244:247], v[56:71]
s_waitcnt lgkmcnt(1)
v_mfma_f32_32x32x16_bf16 v[56:71], v[88:91], v[248:251], v[56:71]
s_waitcnt lgkmcnt(0)
v_mfma_f32_32x32x16_bf16 v[56:71], v[96:99], v[252:255], v[56:71]
s_waitcnt lgkmcnt(15)
s_nop 10
v_pk_fma_f32 v[56:57], v[108:109], v[112:113], v[56:57] op_sel_hi:[0,1,1] neg_lo:[1,0,0] neg_hi:[1,0,0]
v_pk_fma_f32 v[58:59], v[108:109], v[114:115], v[58:59] op_sel_hi:[0,1,1] neg_lo:[1,0,0] neg_hi:[1,0,0]
v_pk_fma_f32 v[60:61], v[108:109], v[116:117], v[60:61] op_sel_hi:[0,1,1] neg_lo:[1,0,0] neg_hi:[1,0,0]
v_pk_fma_f32 v[62:63], v[108:109], v[118:119], v[62:63] op_sel_hi:[0,1,1] neg_lo:[1,0,0] neg_hi:[1,0,0]
v_pk_fma_f32 v[64:65], v[108:109], v[120:121], v[64:65] op_sel_hi:[0,1,1] neg_lo:[1,0,0] neg_hi:[1,0,0]
v_pk_fma_f32 v[66:67], v[108:109], v[122:123], v[66:67] op_sel_hi:[0,1,1] neg_lo:[1,0,0] neg_hi:[1,0,0]
v_pk_fma_f32 v[68:69], v[108:109], v[124:125], v[68:69] op_sel_hi:[0,1,1] neg_lo:[1,0,0] neg_hi:[1,0,0]
v_pk_fma_f32 v[70:71], v[108:109], v[126:127], v[70:71] op_sel_hi:[0,1,1] neg_lo:[1,0,0] neg_hi:[1,0,0]
v_pk_mul_f32 v[56:57], v[106:107], v[56:57] op_sel_hi:[0,1]
v_pk_mul_f32 v[58:59], v[106:107], v[58:59] op_sel_hi:[0,1]
v_pk_mul_f32 v[60:61], v[106:107], v[60:61] op_sel_hi:[0,1]
v_pk_mul_f32 v[62:63], v[106:107], v[62:63] op_sel_hi:[0,1]
v_pk_mul_f32 v[64:65], v[106:107], v[64:65] op_sel_hi:[0,1]
v_pk_mul_f32 v[66:67], v[106:107], v[66:67] op_sel_hi:[0,1]
v_pk_mul_f32 v[68:69], v[106:107], v[68:69] op_sel_hi:[0,1]
v_pk_mul_f32 v[70:71], v[106:107], v[70:71] op_sel_hi:[0,1]
v_cvt_pk_bf16_f32 v56, v56, v57
v_cvt_pk_bf16_f32 v57, v58, v59
v_cvt_pk_bf16_f32 v58, v60, v61
v_cvt_pk_bf16_f32 v59, v62, v63
v_cvt_pk_bf16_f32 v60, v64, v65
v_cvt_pk_bf16_f32 v61, v66, v67
v_cvt_pk_bf16_f32 v62, v68, v69
v_cvt_pk_bf16_f32 v63, v70, v71
s_lshl_b32 s24, s16, 11
s_add_u32 s24, s24, 155648
v_add_u32 v104, s24, v1
ds_write_b128 v104, v[56:59]
ds_write_b128 v104, v[60:63] offset:1024
s_cmp_eq_u32 s14, 0
s_cbranch_scc1 K2R_22
v_lshlrev_b32 v110, 13, v0
s_sub_u32 s24, s28, 8192
v_sub_u32 v110, s24, v110
s_cmp_eq_u32 s14, 1
s_cselect_b32 s26, 1, 3
s_mov_b32 s27, 0
s_mov_b64 exec, s[26:27]
POLL_24:
buffer_load_dword v111, v110, s[4:7], 0 offen sc1
s_waitcnt vmcnt(0)
v_cmp_gt_u32 vcc, 1, v111
s_nop 1
s_cbranch_vccz PX_25
s_sub_u32 s21, s21, 1
s_cbranch_scc1 PX_25_t
s_sleep 2
s_branch POLL_24
PX_25_t:
s_mov_b32 s21, 0
PX_25:
s_mov_b64 exec, -1
K2R_22:
s_sub_u32 s24, s25, 262144
s_cmp_lt_u32 s14, 1
s_cselect_b32 s24, 0x40000000, s24
s_lshl_b32 s26, s16, 12
s_add_u32 s26, s26, 114688
s_mov_b32 m0, s26
s_nop 0
buffer_load_dwordx4 v1, s[4:7], s24 offen offset:0 sc1 lds
buffer_load_dwordx4 v1, s[4:7], s24 offen offset:1024 sc1 lds
buffer_load_dwordx4 v1, s[4:7], s24 offen offset:2048 sc1 lds
buffer_load_dwordx4 v1, s[4:7], s24 offen offset:3072 sc1 lds
s_sub_u32 s24, s25, 524288
s_cmp_lt_u32 s14, 2
s_cselect_b32 s24, 0x40000000, s24
s_sub_u32 s26, s26, 16384
s_mov_b32 m0, s26
s_nop 0
buffer_load_dwordx4 v1, s[4:7], s24 offen offset:0 sc1 lds
buffer_load_dwordx4 v1, s[4:7], s24 offen offset:1024 sc1 lds
buffer_load_dwordx4 v1, s[4:7], s24 offen offset:2048 sc1 lds
buffer_load_dwordx4 v1, s[4:7], s24 offen offset:3072 sc1 lds
s_lshl_b32 s24, s15, 1
s_lshr_b32 s26, s16, 1
s_add_u32 s24, s24, s26
s_mul_i32 s24, s24, 98304
s_add_u32 s24, s24, 3145728
s_lshl_b32 s26, s42, 10
s_add_u32 s38, s24, 32768
s_add_u32 s38, s38, s26
s_lshl_b32 s27, s42, 16
s_add_u32 s24, s24, s27
s_add_u32 s36, s24, s26
s_sub_u32 s37, s24, s26
s_lshl_b32 s26, s42, 8
v_xor_b32 v188, s26, v1
v_mov_b32 v160, s46
v_mov_b32 v161, s46
v_mov_b32 v162, s46
v_mov_b32 v163, s46
v_mov_b32 v164, s46
v_mov_b32 v165, s46
v_mov_b32 v166, s46
v_mov_b32 v167, s46
v_mov_b32 v168, s46
v_mov_b32 v169, s46
v_mov_b32 v170, s46
v_mov_b32 v171, s46
v_mov_b32 v172, s46
v_mov_b32 v173, s46
v_mov_b32 v174, s46
v_mov_b32 v175, s46
v_lshrrev_b32 v25, 5, v0
v_and_b32 v24, 31, v0
v_lshlrev_b32 v25, 2, v25
v_sub_u32 v24, v24, v25
v_cmp_le_i32 s[64:65], 0, v24
v_cmp_le_i32 s[66:67], 1, v24
v_cmp_le_i32 s[68:69], 2, v24
v_cmp_le_i32 s[70:71], 3, v24
v_cmp_le_i32 s[72:73], 8, v24
v_cmp_le_i32 s[74:75], 9, v24
v_cmp_le_i32 s[76:77], 10, v24
v_cmp_le_i32 s[78:79], 11, v24
v_cmp_le_i32 s[80:81], 16, v24
v_cmp_le_i32 s[82:83], 17, v24
v_cmp_le_i32 s[84:85], 18, v24
v_cmp_le_i32 s[86:87], 19, v24
v_cmp_le_i32 s[88:89], 24, v24
v_cmp_le_i32 s[90:91], 25, v24
v_cmp_le_i32 s[92:93], 26, v24
v_cmp_le_i32 s[94:95], 27, v24
v_mov_b32 v25, 0xffff
v_mov_b32 v26, 0xffff0000
v_cndmask_b32 v24, 0, v25, s[64:65]
v_cndmask_b32 v27, 0, v26, s[66:67]
v_or_b32 v4, v24, v27
v_cndmask_b32 v24, 0, v25, s[68:69]
v_cndmask_b32 v27, 0, v26, s[70:71]
v_or_b32 v5, v24, v27
v_cndmask_b32 v24, 0, v25, s[72:73]
v_cndmask_b32 v27, 0, v26, s[74:75]
v_or_b32 v6, v24, v27
v_cndmask_b32 v24, 0, v25, s[76:77]
v_cndmask_b32 v27, 0, v26, s[78:79]
v_or_b32 v7, v24, v27
v_cndmask_b32 v24, 0, v25, s[80:81]
v_cndmask_b32 v27, 0, v26, s[82:83]
v_or_b32 v8, v24, v27
v_cndmask_b32 v24, 0, v25, s[84:85]
v_cndmask_b32 v27, 0, v26, s[86:87]
v_or_b32 v9, v24, v27
v_cndmask_b32 v24, 0, v25, s[88:89]
v_cndmask_b32 v27, 0, v26, s[90:91]
v_or_b32 v10, v24, v27
v_cndmask_b32 v24, 0, v25, s[92:93]
v_cndmask_b32 v27, 0, v26, s[94:95]
v_or_b32 v11, v24, v27
s_lshr_b32 s29, s15, 2
s_lshl_b32 s29, s29, 14
s_add_u32 s29, s29, s41
s_add_u32 s24, s16, s18
s_cmp_lg_u32 s24, 0
s_cbranch_scc1 PRP_26
s_add_u32 s24, s22, 22528
POLL_28:
buffer_load_dword v111, off, s[4:7], s24 sc1
s_waitcnt vmcnt(0)
v_readfirstlane_b32 s23, v111
s_nop 0
s_cmp_ge_u32 s23, 16
s_cbranch_scc1 PX_29
s_sub_u32 s21, s21, 1
s_cbranch_scc1 PX_29_t
s_sleep 2
s_branch POLL_28
PX_29_t:
s_mov_b32 s21, 0
PX_29:
PRP_26:
s_waitcnt vmcnt(0)
s_waitcnt lgkmcnt(0)
s_barrier
s_cmp_lg_u32 s18, 0
s_cselect_b64 vcc, -1, 0
s_lshr_b32 s30, s16, 1
s_add_u32 s30, s30, 0
s_add_u32 s31, s30, 8
s_sub_u32 s31, s31, s19
s_min_u32 s31, s31, 7
s_lshl_b32 s24, s30, 12
s_add_u32 s24, s24, 98304
v_add_u32 v176, s24, v1
s_lshl_b32 s26, s42, 10
v_add_u32 v177, s26, v176
s_lshl_b32 s24, s30, 11
s_add_u32 s24, s24, s26
s_add_u32 s24, s24, 155648
v_add_u32 v178, s24, v1
ds_read_b128 v[24:27], v178
ds_read_b128 v[28:31], v177 offset:32768
ds_read_b128 v[32:35], v177 offset:0
ds_read_b128 v[36:39], v177 offset:28672
ds_read_b128 v[40:43], v177 offset:24576
ds_read_b128 v[44:47], v177 offset:20480
s_waitcnt lgkmcnt(4)
v_mfma_f32_32x32x16_bf16 v[96:111], v[28:31], v[24:27], 0
ds_read_b128 v[48:51], v177 offset:16384
ds_read_b128 v[52:55], v177 offset:12288
s_waitcnt lgkmcnt(5)
v_mfma_f32_32x32x16_bf16 v[112:127], v[32:35], v[24:27], 0
ds_read_b128 v[56:59], v177 offset:8192
ds_read_b128 v[60:63], v177 offset:4096
s_waitcnt lgkmcnt(6)
v_mfma_f32_32x32x16_bf16 v[64:79], v[36:39], v[24:27], 0
s_mov_b64 exec, s[44:45]
ds_read_b128 v[160:163], v176 offset:34816
ds_read_b128 v[164:167], v176 offset:35840
s_mov_b64 exec, -1
s_waitcnt lgkmcnt(7)
v_mfma_f32_32x32x16_bf16 v[80:95], v[40:43], v[24:27], 0
s_mov_b64 exec, s[44:45]
ds_read_b128 v[168:171], v176 offset:2048
ds_read_b128 v[172:175], v176 offset:3072
s_mov_b64 exec, -1
s_cmp_lt_u32 s30, s19
s_cbranch_scc1 FIX_30_s
FIX_30:
v_cndmask_b32 v96, v112, v96, s[64:65]
v_cndmask_b32 v97, v113, v97, s[66:67]
v_cndmask_b32 v98, v114, v98, s[68:69]
v_cndmask_b32 v99, v115, v99, s[70:71]
v_cndmask_b32 v100, v116, v100, s[72:73]
v_cndmask_b32 v101, v117, v101, s[74:75]
v_cndmask_b32 v102, v118, v102, s[76:77]
v_cndmask_b32 v103, v119, v103, s[78:79]
v_cndmask_b32 v104, v120, v104, s[80:81]
v_cndmask_b32 v105, v121, v105, s[82:83]
v_cndmask_b32 v106, v122, v106, s[84:85]
v_cndmask_b32 v107, v123, v107, s[86:87]
v_cndmask_b32 v108, v124, v108, s[88:89]
v_cndmask_b32 v109, v125, v109, s[90:91]
v_cndmask_b32 v110, v126, v110, s[92:93]
v_cndmask_b32 v111, v127, v111, s[94:95]
v_max3_f32 v179, v96, v97, v98
v_max3_f32 v180, v99, v100, v101
v_max3_f32 v180, v102, v103, v180
v_max3_f32 v179, v104, v105, v179
v_max3_f32 v180, v106, v107, v180
v_max3_f32 v179, v108, v109, v179
v_max3_f32 v180, v110, v111, v180
s_waitcnt lgkmcnt(0)
v_mfma_f32_32x32x16_bf16 v[112:127], v[44:47], v[24:27], 0
s_cmp_le_u32 s31, 0
s_cbranch_scc1 K2P1_31
v_max3_f32 v179, v64, v65, v179
v_max3_f32 v180, v66, v67, v180
v_max3_f32 v179, v68, v69, v179
v_max3_f32 v180, v70, v71, v180
v_max3_f32 v179, v72, v73, v179
v_max3_f32 v180, v74, v75, v180
v_max3_f32 v179, v76, v77, v179
v_max3_f32 v180, v78, v79, v180
v_mfma_f32_32x32x16_bf16 v[64:79], v[48:51], v[24:27], 0
s_cmp_le_u32 s31, 1
s_cbranch_scc1 K2P1_31
v_max3_f32 v179, v80, v81, v179
v_max3_f32 v180, v82, v83, v180
v_max3_f32 v179, v84, v85, v179
v_max3_f32 v180, v86, v87, v180
v_max3_f32 v179, v88, v89, v179
v_max3_f32 v180, v90, v91, v180
v_max3_f32 v179, v92, v93, v179
v_max3_f32 v180, v94, v95, v180
v_mfma_f32_32x32x16_bf16 v[80:95], v[52:55], v[24:27], 0
s_cmp_le_u32 s31, 2
s_cbranch_scc1 K2P1_31
v_max3_f32 v179, v112, v113, v179
v_max3_f32 v180, v114, v115, v180
v_max3_f32 v179, v116, v117, v179
v_max3_f32 v180, v118, v119, v180
v_max3_f32 v179, v120, v121, v179
v_max3_f32 v180, v122, v123, v180
v_max3_f32 v179, v124, v125, v179
v_max3_f32 v180, v126, v127, v180
v_mfma_f32_32x32x16_bf16 v[112:127], v[56:59], v[24:27], 0
s_cmp_le_u32 s31, 3
s_cbranch_scc1 K2P1_31
v_max3_f32 v179, v64, v65, v179
v_max3_f32 v180, v66, v67, v180
v_max3_f32 v179, v68, v69, v179
v_max3_f32 v180, v70, v71, v180
v_max3_f32 v179, v72, v73, v179
v_max3_f32 v180, v74, v75, v180
v_max3_f32 v179, v76, v77, v179
v_max3_f32 v180, v78, v79, v180
v_mfma_f32_32x32x16_bf16 v[64:79], v[60:63], v[24:27], 0
s_cmp_le_u32 s31, 4
s_cbranch_scc1 K2P1_31
v_max3_f32 v179, v80, v81, v179
v_max3_f32 v180, v82, v83, v180
v_max3_f32 v179, v84, v85, v179
v_max3_f32 v180, v86, v87, v180
v_max3_f32 v179, v88, v89, v179
v_max3_f32 v180, v90, v91, v180
v_max3_f32 v179, v92, v93, v179
v_max3_f32 v180, v94, v95, v180
s_cmp_le_u32 s31, 5
s_cbranch_scc1 K2P1_31
v_max3_f32 v179, v112, v113, v179
v_max3_f32 v180, v114, v115, v180
v_max3_f32 v179, v116, v117, v179
v_max3_f32 v180, v118, v119, v180
v_max3_f32 v179, v120, v121, v179
v_max3_f32 v180, v122, v123, v180
v_max3_f32 v179, v124, v125, v179
v_max3_f32 v180, v126, v127, v180
s_cmp_le_u32 s31, 6
s_cbranch_scc1 K2P1_31
v_max3_f32 v179, v64, v65, v179
v_max3_f32 v180, v66, v67, v180
v_max3_f32 v179, v68, v69, v179
v_max3_f32 v180, v70, v71, v180
v_max3_f32 v179, v72, v73, v179
v_max3_f32 v180, v74, v75, v180
v_max3_f32 v179, v76, v77, v179
v_max3_f32 v180, v78, v79, v180
K2P1_31:
v_max_f32 v179, v179, v180
v_mov_b32 v180, v179
s_nop 1
v_permlane32_swap_b32 v179, v180
v_max_f32 v179, v179, v180
v_sub_f32 v182, 0, v179
v_pk_add_f32 v[96:97], v[182:183], v[96:97] op_sel_hi:[0,1]
v_pk_add_f32 v[98:99], v[182:183], v[98:99] op_sel_hi:[0,1]
v_pk_add_f32 v[100:101], v[182:183], v[100:101] op_sel_hi:[0,1]
v_pk_add_f32 v[102:103], v[182:183], v[102:103] op_sel_hi:[0,1]
v_pk_add_f32 v[104:105], v[182:183], v[104:105] op_sel_hi:[0,1]
v_pk_add_f32 v[106:107], v[182:183], v[106:107] op_sel_hi:[0,1]
v_pk_add_f32 v[108:109], v[182:183], v[108:109] op_sel_hi:[0,1]
v_pk_add_f32 v[110:111], v[182:183], v[110:111] op_sel_hi:[0,1]
v_pk_mov_b32 v[112:113], v[182:183], v[182:183] op_sel:[0,0]
v_pk_mov_b32 v[114:115], v[182:183], v[182:183] op_sel:[0,0]
v_pk_mov_b32 v[116:117], v[182:183], v[182:183] op_sel:[0,0]
v_pk_mov_b32 v[118:119], v[182:183], v[182:183] op_sel:[0,0]
v_pk_mov_b32 v[120:121], v[182:183], v[182:183] op_sel:[0,0]
v_pk_mov_b32 v[122:123], v[182:183], v[182:183] op_sel:[0,0]
v_pk_mov_b32 v[124:125], v[182:183], v[182:183] op_sel:[0,0]
v_pk_mov_b32 v[126:127], v[182:183], v[182:183] op_sel:[0,0]
s_cmp_eq_u32 s31, 0
s_cbranch_scc1 FIX_32_s
FIX_32:
v_mfma_f32_32x32x16_bf16 v[64:79], v[36:39], v[24:27], v[112:127]
v_exp_f32 v96, v96
v_exp_f32 v97, v97
v_exp_f32 v98, v98
v_exp_f32 v99, v99
v_exp_f32 v100, v100
v_exp_f32 v101, v101
v_exp_f32 v102, v102
v_exp_f32 v103, v103
s_cbranch_vccz GW_33_s
GW_33:
v_exp_f32 v104, v104
v_exp_f32 v105, v105
v_exp_f32 v106, v106
v_exp_f32 v107, v107
v_exp_f32 v108, v108
v_exp_f32 v109, v109
v_exp_f32 v110, v110
v_exp_f32 v111, v111
v_cvt_pk_bf16_f32 v152, v96, v97
v_cvt_pk_bf16_f32 v153, v98, v99
v_cvt_pk_bf16_f32 v154, v100, v101
v_cvt_pk_bf16_f32 v155, v102, v103
v_cvt_pk_bf16_f32 v156, v104, v105
v_cvt_pk_bf16_f32 v157, v106, v107
v_cvt_pk_bf16_f32 v158, v108, v109
v_cvt_pk_bf16_f32 v159, v110, v111
v_and_b32 v144, v4, v152
v_and_b32 v145, v5, v153
v_and_b32 v146, v6, v154
v_and_b32 v147, v7, v155
v_and_b32 v148, v8, v156
v_and_b32 v149, v9, v157
v_and_b32 v150, v10, v158
v_and_b32 v151, v11, v159
buffer_load_dwordx4 a[192:195], v1, s[4:7], s35 offen offset:0 sc1
buffer_load_dwordx4 a[196:199], v1, s[4:7], s35 offen offset:1024 sc1
v_mfma_f32_32x32x16_bf16 v[128:143], v[160:163], v[144:147], 0
v_xor_b32 v152, v144, v152
v_xor_b32 v153, v145, v153
v_xor_b32 v154, v146, v154
v_xor_b32 v155, v147, v155
v_xor_b32 v156, v148, v156
v_xor_b32 v157, v149, v157
v_xor_b32 v158, v150, v158
v_xor_b32 v159, v151, v159
v_mfma_f32_32x32x16_bf16 v[128:143], v[164:167], v[148:151], v[128:143]
s_cmp_eq_u32 s31, 1
s_cbranch_scc1 FIX_34_s
FIX_34:
v_mfma_f32_32x32x16_bf16 v[80:95], v[40:43], v[24:27], v[112:127]
s_mov_b64 exec, s[44:45]
ds_read_b128 v[160:163], v176 offset:30720
ds_read_b128 v[164:167], v176 offset:31744
s_mov_b64 exec, -1
v_exp_f32 v64, v64
v_exp_f32 v65, v65
v_exp_f32 v66, v66
v_exp_f32 v67, v67
v_mfma_f32_32x32x16_bf16 v[128:143], v[168:171], v[152:155], v[128:143]
v_exp_f32 v68, v68
v_exp_f32 v69, v69
v_exp_f32 v70, v70
v_exp_f32 v71, v71
v_mfma_f32_32x32x16_bf16 v[128:143], v[172:175], v[156:159], v[128:143]
v_cvt_pk_bf16_f32 v144, v64, v65
v_cvt_pk_bf16_f32 v145, v66, v67
v_cvt_pk_bf16_f32 v146, v68, v69
v_cvt_pk_bf16_f32 v147, v70, v71
s_mov_b64 exec, s[44:45]
ds_read_b128 v[168:171], v176 offset:26624
ds_read_b128 v[172:175], v176 offset:27648
s_mov_b64 exec, -1
v_exp_f32 v72, v72
s_waitcnt lgkmcnt(2)
v_mfma_f32_32x32x16_bf16 v[128:143], v[160:163], v[144:147], v[128:143]
v_exp_f32 v73, v73
v_exp_f32 v74, v74
v_exp_f32 v75, v75
v_exp_f32 v76, v76
s_cbranch_vccz GW_35_s
GW_35:
v_exp_f32 v77, v77
v_exp_f32 v78, v78
v_exp_f32 v79, v79
v_cvt_pk_bf16_f32 v148, v72, v73
v_cvt_pk_bf16_f32 v149, v74, v75
v_cvt_pk_bf16_f32 v150, v76, v77
v_cvt_pk_bf16_f32 v151, v78, v79
buffer_load_dwordx4 a[200:203], v1, s[4:7], s35 offen offset:2048 sc1
buffer_load_dwordx4 a[204:207], v1, s[4:7], s35 offen offset:3072 sc1
s_add_u32 s35, s35, 4096
v_mfma_f32_32x32x16_bf16 v[128:143], v[164:167], v[148:151], v[128:143]
s_cmp_eq_u32 s31, 2
s_cbranch_scc1 FIX_36_s
FIX_36:
v_mfma_f32_32x32x16_bf16 v[64:79], v[44:47], v[24:27], v[112:127]
s_mov_b64 exec, s[44:45]
ds_read_b128 v[160:163], v176 offset:22528
ds_read_b128 v[164:167], v176 offset:23552
s_mov_b64 exec, -1
v_exp_f32 v80, v80
v_exp_f32 v81, v81
v_exp_f32 v82, v82
v_exp_f32 v83, v83
s_cbranch_vccz GW_37_s
GW_37:
v_exp_f32 v84, v84
v_exp_f32 v85, v85
v_exp_f32 v86, v86
v_exp_f32 v87, v87
v_cvt_pk_bf16_f32 v144, v80, v81
v_cvt_pk_bf16_f32 v145, v82, v83
v_cvt_pk_bf16_f32 v146, v84, v85
v_cvt_pk_bf16_f32 v147, v86, v87
v_exp_f32 v88, v88
s_waitcnt lgkmcnt(2)
v_mfma_f32_32x32x16_bf16 v[128:143], v[168:171], v[144:147], v[128:143]
v_exp_f32 v89, v89
v_exp_f32 v90, v90
v_exp_f32 v91, v91
v_exp_f32 v92, v92
buffer_load_dwordx4 a[208:211], v1, s[4:7], s35 offen offset:0 sc1
buffer_load_dwordx4 a[212:215], v1, s[4:7], s35 offen offset:1024 sc1
v_exp_f32 v93, v93
v_exp_f32 v94, v94
v_exp_f32 v95, v95
v_cvt_pk_bf16_f32 v148, v88, v89
v_cvt_pk_bf16_f32 v149, v90, v91
v_cvt_pk_bf16_f32 v150, v92, v93
v_cvt_pk_bf16_f32 v151, v94, v95
s_cbranch_vccz GW_38_s
GW_38:
s_nop 0
v_mfma_f32_32x32x16_bf16 v[128:143], v[172:175], v[148:151], v[128:143]
s_cmp_eq_u32 s31, 3
s_cbranch_scc1 FIX_39_s
FIX_39:
v_mfma_f32_32x32x16_bf16 v[80:95], v[48:51], v[24:27], v[112:127]
s_mov_b64 exec, s[44:45]
ds_read_b128 v[168:171], v176 offset:18432
ds_read_b128 v[172:175], v176 offset:19456
s_mov_b64 exec, -1
v_exp_f32 v64, v64
v_exp_f32 v65, v65
v_exp_f32 v66, v66
v_exp_f32 v67, v67
buffer_load_dwordx4 a[216:219], v1, s[4:7], s35 offen offset:2048 sc1
buffer_load_dwordx4 a[220:223], v1, s[4:7], s35 offen offset:3072 sc1
s_add_u32 s35, s35, 4096
v_exp_f32 v68, v68
v_exp_f32 v69, v69
v_exp_f32 v70, v70
v_exp_f32 v71, v71
v_cvt_pk_bf16_f32 v144, v64, v65
v_cvt_pk_bf16_f32 v145, v66, v67
v_cvt_pk_bf16_f32 v146, v68, v69
v_cvt_pk_bf16_f32 v147, v70, v71
v_exp_f32 v72, v72
s_waitcnt lgkmcnt(2)
v_mfma_f32_32x32x16_bf16 v[128:143], v[160:163], v[144:147], v[128:143]
v_exp_f32 v73, v73
v_exp_f32 v74, v74
v_exp_f32 v75, v75
v_exp_f32 v76, v76
s_cbranch_vccz GW_40_s
GW_40:
v_exp_f32 v77, v77
v_exp_f32 v78, v78
v_exp_f32 v79, v79
v_cvt_pk_bf16_f32 v148, v72, v73
v_cvt_pk_bf16_f32 v149, v74, v75
v_cvt_pk_bf16_f32 v150, v76, v77
v_cvt_pk_bf16_f32 v151, v78, v79
buffer_load_dwordx4 a[224:227], v1, s[4:7], s35 offen offset:0 sc1
buffer_load_dwordx4 a[228:231], v1, s[4:7], s35 offen offset:1024 sc1
v_mfma_f32_32x32x16_bf16 v[128:143], v[164:167], v[148:151], v[128:143]
s_cmp_eq_u32 s31, 4
s_cbranch_scc1 FIX_41_s
FIX_41:
v_mfma_f32_32x32x16_bf16 v[64:79], v[52:55], v[24:27], v[112:127]
s_mov_b64 exec, s[44:45]
ds_read_b128 v[160:163], v176 offset:14336
ds_read_b128 v[164:167], v176 offset:15360
s_mov_b64 exec, -1
v_exp_f32 v80, v80
v_exp_f32 v81, v81
v_exp_f32 v82, v82
v_exp_f32 v83, v83
s_cbranch_vccz GW_42_s
GW_42:
v_exp_f32 v84, v84
v_exp_f32 v85, v85
v_exp_f32 v86, v86
v_exp_f32 v87, v87
v_cvt_pk_bf16_f32 v144, v80, v81
v_cvt_pk_bf16_f32 v145, v82, v83
v_cvt_pk_bf16_f32 v146, v84, v85
v_cvt_pk_bf16_f32 v147, v86, v87
v_exp_f32 v88, v88
s_waitcnt lgkmcnt(2)
v_mfma_f32_32x32x16_bf16 v[128:143], v[168:171], v[144:147], v[128:143]
v_exp_f32 v89, v89
v_exp_f32 v90, v90
v_exp_f32 v91, v91
v_exp_f32 v92, v92
buffer_load_dwordx4 a[232:235], v1, s[4:7], s35 offen offset:2048 sc1
buffer_load_dwordx4 a[236:239], v1, s[4:7], s35 offen offset:3072 sc1
s_add_u32 s35, s35, 4096
v_exp_f32 v93, v93
v_exp_f32 v94, v94
v_exp_f32 v95, v95
v_cvt_pk_bf16_f32 v148, v88, v89
v_cvt_pk_bf16_f32 v149, v90, v91
v_cvt_pk_bf16_f32 v150, v92, v93
v_cvt_pk_bf16_f32 v151, v94, v95
s_cbranch_vccz GW_43_s
GW_43:
s_nop 0
v_mfma_f32_32x32x16_bf16 v[128:143], v[172:175], v[148:151], v[128:143]
s_cmp_eq_u32 s31, 5
s_cbranch_scc1 FIX_44_s
FIX_44:
v_mfma_f32_32x32x16_bf16 v[80:95], v[56:59], v[24:27], v[112:127]
s_mov_b64 exec, s[44:45]
ds_read_b128 v[168:171], v176 offset:10240
ds_read_b128 v[172:175], v176 offset:11264
s_mov_b64 exec, -1
v_exp_f32 v64, v64
v_exp_f32 v65, v65
v_exp_f32 v66, v66
v_exp_f32 v67, v67
buffer_load_dwordx4 a[240:243], v1, s[4:7], s35 offen offset:0 sc1
buffer_load_dwordx4 a[244:247], v1, s[4:7], s35 offen offset:1024 sc1
v_exp_f32 v68, v68
v_exp_f32 v69, v69
v_exp_f32 v70, v70
v_exp_f32 v71, v71
v_cvt_pk_bf16_f32 v144, v64, v65
v_cvt_pk_bf16_f32 v145, v66, v67
v_cvt_pk_bf16_f32 v146, v68, v69
v_cvt_pk_bf16_f32 v147, v70, v71
v_exp_f32 v72, v72
s_waitcnt lgkmcnt(2)
v_mfma_f32_32x32x16_bf16 v[128:143], v[160:163], v[144:147], v[128:143]
v_exp_f32 v73, v73
v_exp_f32 v74, v74
v_exp_f32 v75, v75
v_exp_f32 v76, v76
s_cbranch_vccz GW_45_s
GW_45:
v_exp_f32 v77, v77
v_exp_f32 v78, v78
v_exp_f32 v79, v79
v_cvt_pk_bf16_f32 v148, v72, v73
v_cvt_pk_bf16_f32 v149, v74, v75
v_cvt_pk_bf16_f32 v150, v76, v77
v_cvt_pk_bf16_f32 v151, v78, v79
buffer_load_dwordx4 a[248:251], v1, s[4:7], s35 offen offset:2048 sc1
buffer_load_dwordx4 a[252:255], v1, s[4:7], s35 offen offset:3072 sc1
s_add_u32 s35, s35, 4096
v_mfma_f32_32x32x16_bf16 v[128:143], v[164:167], v[148:151], v[128:143]
s_cmp_eq_u32 s31, 6
s_cbranch_scc1 FIX_46_s
FIX_46:
v_mfma_f32_32x32x16_bf16 v[64:79], v[60:63], v[24:27], v[112:127]
s_mov_b64 exec, s[44:45]
ds_read_b128 v[160:163], v176 offset:6144
ds_read_b128 v[164:167], v176 offset:7168
s_mov_b64 exec, -1
v_exp_f32 v80, v80
v_exp_f32 v81, v81
v_exp_f32 v82, v82
v_exp_f32 v83, v83
s_cbranch_vccz GW_47_s
GW_47:
v_exp_f32 v84, v84
v_exp_f32 v85, v85
v_exp_f32 v86, v86
v_exp_f32 v87, v87
v_cvt_pk_bf16_f32 v144, v80, v81
v_cvt_pk_bf16_f32 v145, v82, v83
v_cvt_pk_bf16_f32 v146, v84, v85
v_cvt_pk_bf16_f32 v147, v86, v87
v_exp_f32 v88, v88
s_waitcnt lgkmcnt(2)
v_mfma_f32_32x32x16_bf16 v[128:143], v[168:171], v[144:147], v[128:143]
v_exp_f32 v89, v89
v_exp_f32 v90, v90
v_exp_f32 v91, v91
v_exp_f32 v92, v92
buffer_load_dwordx4 v[192:195], v1, s[4:7], s35 offen offset:0 sc1
buffer_load_dwordx4 v[196:199], v1, s[4:7], s35 offen offset:1024 sc1
v_exp_f32 v93, v93
v_exp_f32 v94, v94
v_exp_f32 v95, v95
v_cvt_pk_bf16_f32 v148, v88, v89
v_cvt_pk_bf16_f32 v149, v90, v91
v_cvt_pk_bf16_f32 v150, v92, v93
v_cvt_pk_bf16_f32 v151, v94, v95
s_cbranch_vccz GW_48_s
GW_48:
s_nop 0
v_mfma_f32_32x32x16_bf16 v[128:143], v[172:175], v[148:151], v[128:143]
v_exp_f32 v64, v64
v_exp_f32 v65, v65
v_exp_f32 v66, v66
v_exp_f32 v67, v67
buffer_load_dwordx4 v[200:203], v1, s[4:7], s35 offen offset:2048 sc1
buffer_load_dwordx4 v[204:207], v1, s[4:7], s35 offen offset:3072 sc1
s_add_u32 s35, s35, 4096
v_exp_f32 v68, v68
v_exp_f32 v69, v69
v_exp_f32 v70, v70
v_exp_f32 v71, v71
v_cvt_pk_bf16_f32 v144, v64, v65
v_cvt_pk_bf16_f32 v145, v66, v67
v_cvt_pk_bf16_f32 v146, v68, v69
v_cvt_pk_bf16_f32 v147, v70, v71
v_exp_f32 v72, v72
s_waitcnt lgkmcnt(0)
v_mfma_f32_32x32x16_bf16 v[128:143], v[160:163], v[144:147], v[128:143]
v_exp_f32 v73, v73
v_exp_f32 v74, v74
v_exp_f32 v75, v75
v_exp_f32 v76, v76
s_cbranch_vccz GW_49_s
GW_49:
v_exp_f32 v77, v77
v_exp_f32 v78, v78
v_exp_f32 v79, v79
v_cvt_pk_bf16_f32 v148, v72, v73
v_cvt_pk_bf16_f32 v149, v74, v75
v_cvt_pk_bf16_f32 v150, v76, v77
v_cvt_pk_bf16_f32 v151, v78, v79
buffer_load_dwordx4 v[208:211], v1, s[4:7], s35 offen offset:0 sc1
buffer_load_dwordx4 v[212:215], v1, s[4:7], s35 offen offset:1024 sc1
v_mfma_f32_32x32x16_bf16 v[128:143], v[164:167], v[148:151], v[128:143]
s_lshl_b32 s24, s30, 15
s_add_u32 s24, s24, s41
s_lshl_b32 s26, s15, 1
s_add_u32 s26, s26, s42
s_lshl_b32 s26, s26, 9
s_add_u32 s24, s24, s26
s_add_u32 s24, s24, s17
s_add_u32 s59, s24, 4194304
s_nop 3
s_cmp_lg_u32 s42, 0
s_cbranch_scc1 K2H_50
v_rcp_f32 v182, v136
s_nop 0
v_pk_mul_f32 v[128:129], v[182:183], v[128:129] op_sel_hi:[0,1]
v_pk_mul_f32 v[130:131], v[182:183], v[130:131] op_sel_hi:[0,1]
v_pk_mul_f32 v[132:133], v[182:183], v[132:133] op_sel_hi:[0,1]
v_pk_mul_f32 v[134:135], v[182:183], v[134:135] op_sel_hi:[0,1]
s_branch K2H_51
K2H_50:
v_rcp_f32 v182, v128
s_nop 0
v_pk_mul_f32 v[128:129], v[182:183], v[136:137] op_sel_hi:[0,1]
v_pk_mul_f32 v[130:131], v[182:183], v[138:139] op_sel_hi:[0,1]
v_pk_mul_f32 v[132:133], v[182:183], v[140:141] op_sel_hi:[0,1]
v_pk_mul_f32 v[134:135], v[182:183], v[142:143] op_sel_hi:[0,1]
K2H_51:
v_cvt_pk_bf16_f32 v184, v128, v129
v_cvt_pk_bf16_f32 v185, v130, v131
v_cvt_pk_bf16_f32 v186, v132, v133
v_cvt_pk_bf16_f32 v187, v134, v135
buffer_store_dwordx4 v[184:187], v2, s[4:7], s59 offen sc1
s_lshr_b32 s30, s16, 1
s_add_u32 s30, s30, 2
s_add_u32 s31, s30, 8
s_sub_u32 s31, s31, s19
s_min_u32 s31, s31, 7
s_lshl_b32 s24, s30, 12
s_add_u32 s24, s24, 98304
v_add_u32 v176, s24, v1
s_lshl_b32 s26, s42, 10
v_add_u32 v177, s26, v176
s_lshl_b32 s24, s30, 11
s_add_u32 s24, s24, s26
s_add_u32 s24, s24, 155648
v_add_u32 v178, s24, v1
ds_read_b128 v[24:27], v178
ds_read_b128 v[28:31], v177 offset:32768
ds_read_b128 v[32:35], v177 offset:0
ds_read_b128 v[36:39], v177 offset:28672
ds_read_b128 v[40:43], v177 offset:24576
ds_read_b128 v[44:47], v177 offset:20480
s_waitcnt lgkmcnt(4)
v_mfma_f32_32x32x16_bf16 v[96:111], v[28:31], v[24:27], 0
ds_read_b128 v[48:51], v177 offset:16384
ds_read_b128 v[52:55], v177 offset:12288
s_waitcnt lgkmcnt(5)
v_mfma_f32_32x32x16_bf16 v[112:127], v[32:35], v[24:27], 0
ds_read_b128 v[56:59], v177 offset:8192
ds_read_b128 v[60:63], v177 offset:4096
s_waitcnt lgkmcnt(6)
v_mfma_f32_32x32x16_bf16 v[64:79], v[36:39], v[24:27], 0
s_mov_b64 exec, s[44:45]
ds_read_b128 v[160:163], v176 offset:34816
ds_read_b128 v[164:167], v176 offset:35840
s_mov_b64 exec, -1
s_waitcnt lgkmcnt(7)
v_mfma_f32_32x32x16_bf16 v[80:95], v[40:43], v[24:27], 0
s_mov_b64 exec, s[44:45]
ds_read_b128 v[168:171], v176 offset:2048
ds_read_b128 v[172:175], v176 offset:3072
s_mov_b64 exec, -1
s_cmp_lt_u32 s30, s19
s_cbranch_scc1 FIX_52_s
FIX_52:
v_cndmask_b32 v96, v112, v96, s[64:65]
v_cndmask_b32 v97, v113, v97, s[66:67]
v_cndmask_b32 v98, v114, v98, s[68:69]
v_cndmask_b32 v99, v115, v99, s[70:71]
v_cndmask_b32 v100, v116, v100, s[72:73]
v_cndmask_b32 v101, v117, v101, s[74:75]
v_cndmask_b32 v102, v118, v102, s[76:77]
v_cndmask_b32 v103, v119, v103, s[78:79]
v_cndmask_b32 v104, v120, v104, s[80:81]
v_cndmask_b32 v105, v121, v105, s[82:83]
v_cndmask_b32 v106, v122, v106, s[84:85]
v_cndmask_b32 v107, v123, v107, s[86:87]
v_cndmask_b32 v108, v124, v108, s[88:89]
v_cndmask_b32 v109, v125, v109, s[90:91]
v_cndmask_b32 v110, v126, v110, s[92:93]
v_cndmask_b32 v111, v127, v111, s[94:95]
v_max3_f32 v179, v96, v97, v98
v_max3_f32 v180, v99, v100, v101
v_max3_f32 v180, v102, v103, v180
v_max3_f32 v179, v104, v105, v179
v_max3_f32 v180, v106, v107, v180
v_max3_f32 v179, v108, v109, v179
v_max3_f32 v180, v110, v111, v180
s_waitcnt lgkmcnt(0)
v_mfma_f32_32x32x16_bf16 v[112:127], v[44:47], v[24:27], 0
s_cmp_le_u32 s31, 0
s_cbranch_scc1 K2P1_53
v_max3_f32 v179, v64, v65, v179
v_max3_f32 v180, v66, v67, v180
v_max3_f32 v179, v68, v69, v179
v_max3_f32 v180, v70, v71, v180
v_max3_f32 v179, v72, v73, v179
v_max3_f32 v180, v74, v75, v180
v_max3_f32 v179, v76, v77, v179
v_max3_f32 v180, v78, v79, v180
v_mfma_f32_32x32x16_bf16 v[64:79], v[48:51], v[24:27], 0
s_cmp_le_u32 s31, 1
s_cbranch_scc1 K2P1_53
v_max3_f32 v179, v80, v81, v179
v_max3_f32 v180, v82, v83, v180
v_max3_f32 v179, v84, v85, v179
v_max3_f32 v180, v86, v87, v180
v_max3_f32 v179, v88, v89, v179
v_max3_f32 v180, v90, v91, v180
v_max3_f32 v179, v92, v93, v179
v_max3_f32 v180, v94, v95, v180
v_mfma_f32_32x32x16_bf16 v[80:95], v[52:55], v[24:27], 0
s_cmp_le_u32 s31, 2
s_cbranch_scc1 K2P1_53
v_max3_f32 v179, v112, v113, v179
v_max3_f32 v180, v114, v115, v180
v_max3_f32 v179, v116, v117, v179
v_max3_f32 v180, v118, v119, v180
v_max3_f32 v179, v120, v121, v179
v_max3_f32 v180, v122, v123, v180
v_max3_f32 v179, v124, v125, v179
v_max3_f32 v180, v126, v127, v180
v_mfma_f32_32x32x16_bf16 v[112:127], v[56:59], v[24:27], 0
s_cmp_le_u32 s31, 3
s_cbranch_scc1 K2P1_53
v_max3_f32 v179, v64, v65, v179
v_max3_f32 v180, v66, v67, v180
v_max3_f32 v179, v68, v69, v179
v_max3_f32 v180, v70, v71, v180
v_max3_f32 v179, v72, v73, v179
v_max3_f32 v180, v74, v75, v180
v_max3_f32 v179, v76, v77, v179
v_max3_f32 v180, v78, v79, v180
v_mfma_f32_32x32x16_bf16 v[64:79], v[60:63], v[24:27], 0
s_cmp_le_u32 s31, 4
s_cbranch_scc1 K2P1_53
v_max3_f32 v179, v80, v81, v179
v_max3_f32 v180, v82, v83, v180
v_max3_f32 v179, v84, v85, v179
v_max3_f32 v180, v86, v87, v180
v_max3_f32 v179, v88, v89, v179
v_max3_f32 v180, v90, v91, v180
v_max3_f32 v179, v92, v93, v179
v_max3_f32 v180, v94, v95, v180
s_cmp_le_u32 s31, 5
s_cbranch_scc1 K2P1_53
v_max3_f32 v179, v112, v113, v179
v_max3_f32 v180, v114, v115, v180
v_max3_f32 v179, v116, v117, v179
v_max3_f32 v180, v118, v119, v180
v_max3_f32 v179, v120, v121, v179
v_max3_f32 v180, v122, v123, v180
v_max3_f32 v179, v124, v125, v179
v_max3_f32 v180, v126, v127, v180
s_cmp_le_u32 s31, 6
s_cbranch_scc1 K2P1_53
v_max3_f32 v179, v64, v65, v179
v_max3_f32 v180, v66, v67, v180
v_max3_f32 v179, v68, v69, v179
v_max3_f32 v180, v70, v71, v180
v_max3_f32 v179, v72, v73, v179
v_max3_f32 v180, v74, v75, v180
v_max3_f32 v179, v76, v77, v179
v_max3_f32 v180, v78, v79, v180
K2P1_53:
v_max_f32 v179, v179, v180
v_mov_b32 v180, v179
s_nop 1
v_permlane32_swap_b32 v179, v180
v_max_f32 v179, v179, v180
v_sub_f32 v182, 0, v179
v_pk_add_f32 v[96:97], v[182:183], v[96:97] op_sel_hi:[0,1]
v_pk_add_f32 v[98:99], v[182:183], v[98:99] op_sel_hi:[0,1]
v_pk_add_f32 v[100:101], v[182:183], v[100:101] op_sel_hi:[0,1]
v_pk_add_f32 v[102:103], v[182:183], v[102:103] op_sel_hi:[0,1]
v_pk_add_f32 v[104:105], v[182:183], v[104:105] op_sel_hi:[0,1]
v_pk_add_f32 v[106:107], v[182:183], v[106:107] op_sel_hi:[0,1]
v_pk_add_f32 v[108:109], v[182:183], v[108:109] op_sel_hi:[0,1]
v_pk_add_f32 v[110:111], v[182:183], v[110:111] op_sel_hi:[0,1]
v_pk_mov_b32 v[112:113], v[182:183], v[182:183] op_sel:[0,0]
v_pk_mov_b32 v[114:115], v[182:183], v[182:183] op_sel:[0,0]
v_pk_mov_b32 v[116:117], v[182:183], v[182:183] op_sel:[0,0]
v_pk_mov_b32 v[118:119], v[182:183], v[182:183] op_sel:[0,0]
v_pk_mov_b32 v[120:121], v[182:183], v[182:183] op_sel:[0,0]
v_pk_mov_b32 v[122:123], v[182:183], v[182:183] op_sel:[0,0]
v_pk_mov_b32 v[124:125], v[182:183], v[182:183] op_sel:[0,0]
v_pk_mov_b32 v[126:127], v[182:183], v[182:183] op_sel:[0,0]
s_cmp_eq_u32 s31, 0
s_cbranch_scc1 FIX_54_s
FIX_54:
v_mfma_f32_32x32x16_bf16 v[64:79], v[36:39], v[24:27], v[112:127]
s_waitcnt vmcnt(0)
s_cmp_eq_u32 s16, 3
s_barrier
s_cbranch_scc1 SIG_55_s
SIG_55:
buffer_load_dword v181, v2, s[4:7], s59 offen offset:0 sc1
v_exp_f32 v96, v96
v_exp_f32 v97, v97
v_exp_f32 v98, v98
v_exp_f32 v99, v99
v_exp_f32 v100, v100
v_exp_f32 v101, v101
v_exp_f32 v102, v102
v_exp_f32 v103, v103
s_cbranch_vccz GW_56_s
GW_56:
v_exp_f32 v104, v104
v_exp_f32 v105, v105
v_exp_f32 v106, v106
v_exp_f32 v107, v107
v_exp_f32 v108, v108
v_exp_f32 v109, v109
v_exp_f32 v110, v110
v_exp_f32 v111, v111
v_cvt_pk_bf16_f32 v152, v96, v97
v_cvt_pk_bf16_f32 v153, v98, v99
v_cvt_pk_bf16_f32 v154, v100, v101
v_cvt_pk_bf16_f32 v155, v102, v103
v_cvt_pk_bf16_f32 v156, v104, v105
v_cvt_pk_bf16_f32 v157, v106, v107
v_cvt_pk_bf16_f32 v158, v108, v109
v_cvt_pk_bf16_f32 v159, v110, v111
v_and_b32 v144, v4, v152
v_and_b32 v145, v5, v153
v_and_b32 v146, v6, v154
v_and_b32 v147, v7, v155
v_and_b32 v148, v8, v156
v_and_b32 v149, v9, v157
v_and_b32 v150, v10, v158
v_and_b32 v151, v11, v159
buffer_load_dwordx4 v[216:219], v1, s[4:7], s35 offen offset:2048 sc1
buffer_load_dwordx4 v[220:223], v1, s[4:7], s35 offen offset:3072 sc1
s_add_u32 s35, s35, 4096
v_mfma_f32_32x32x16_bf16 v[128:143], v[160:163], v[144:147], 0
v_xor_b32 v152, v144, v152
v_xor_b32 v153, v145, v153
v_xor_b32 v154, v146, v154
v_xor_b32 v155, v147, v155
v_xor_b32 v156, v148, v156
v_xor_b32 v157, v149, v157
v_xor_b32 v158, v150, v158
v_xor_b32 v159, v151, v159
v_mfma_f32_32x32x16_bf16 v[128:143], v[164:167], v[148:151], v[128:143]
s_cmp_eq_u32 s31, 1
s_cbranch_scc1 FIX_57_s
FIX_57:
v_mfma_f32_32x32x16_bf16 v[80:95], v[40:43], v[24:27], v[112:127]
s_mov_b64 exec, s[44:45]
ds_read_b128 v[160:163], v176 offset:30720
ds_read_b128 v[164:167], v176 offset:31744
s_mov_b64 exec, -1
v_exp_f32 v64, v64
v_exp_f32 v65, v65
v_exp_f32 v66, v66
v_exp_f32 v67, v67
v_mfma_f32_32x32x16_bf16 v[128:143], v[168:171], v[152:155], v[128:143]
v_exp_f32 v68, v68
v_exp_f32 v69, v69
v_exp_f32 v70, v70
v_exp_f32 v71, v71
v_mfma_f32_32x32x16_bf16 v[128:143], v[172:175], v[156:159], v[128:143]
v_cvt_pk_bf16_f32 v144, v64, v65
v_cvt_pk_bf16_f32 v145, v66, v67
v_cvt_pk_bf16_f32 v146, v68, v69
v_cvt_pk_bf16_f32 v147, v70, v71
s_mov_b64 exec, s[44:45]
ds_read_b128 v[168:171], v176 offset:26624
ds_read_b128 v[172:175], v176 offset:27648
s_mov_b64 exec, -1
v_exp_f32 v72, v72
s_waitcnt lgkmcnt(2)
v_mfma_f32_32x32x16_bf16 v[128:143], v[160:163], v[144:147], v[128:143]
v_exp_f32 v73, v73
v_exp_f32 v74, v74
v_exp_f32 v75, v75
v_exp_f32 v76, v76
s_cbranch_vccz GW_58_s
GW_58:
v_exp_f32 v77, v77
v_exp_f32 v78, v78
v_exp_f32 v79, v79
v_cvt_pk_bf16_f32 v148, v72, v73
v_cvt_pk_bf16_f32 v149, v74, v75
v_cvt_pk_bf16_f32 v150, v76, v77
v_cvt_pk_bf16_f32 v151, v78, v79
buffer_load_dwordx4 v[224:227], v1, s[4:7], s35 offen offset:0 sc1
buffer_load_dwordx4 v[228:231], v1, s[4:7], s35 offen offset:1024 sc1
v_mfma_f32_32x32x16_bf16 v[128:143], v[164:167], v[148:151], v[128:143]
s_cmp_eq_u32 s31, 2
s_cbranch_scc1 FIX_59_s
FIX_59:
v_mfma_f32_32x32x16_bf16 v[64:79], v[44:47], v[24:27], v[112:127]
s_mov_b64 exec, s[44:45]
ds_read_b128 v[160:163], v176 offset:22528
ds_read_b128 v[164:167], v176 offset:23552
s_mov_b64 exec, -1
v_exp_f32 v80, v80
v_exp_f32 v81, v81
v_exp_f32 v82, v82
v_exp_f32 v83, v83
s_cbranch_vccz GW_60_s
GW_60:
v_exp_f32 v84, v84
v_exp_f32 v85, v85
v_exp_f32 v86, v86
v_exp_f32 v87, v87
v_cvt_pk_bf16_f32 v144, v80, v81
v_cvt_pk_bf16_f32 v145, v82, v83
v_cvt_pk_bf16_f32 v146, v84, v85
v_cvt_pk_bf16_f32 v147, v86, v87
v_exp_f32 v88, v88
s_waitcnt lgkmcnt(2)
v_mfma_f32_32x32x16_bf16 v[128:143], v[168:171], v[144:147], v[128:143]
v_exp_f32 v89, v89
v_exp_f32 v90, v90
v_exp_f32 v91, v91
v_exp_f32 v92, v92
buffer_load_dwordx4 v[232:235], v1, s[4:7], s35 offen offset:2048 sc1
buffer_load_dwordx4 v[236:239], v1, s[4:7], s35 offen offset:3072 sc1
s_add_u32 s35, s35, 4096
v_exp_f32 v93, v93
v_exp_f32 v94, v94
v_exp_f32 v95, v95
v_cvt_pk_bf16_f32 v148, v88, v89
v_cvt_pk_bf16_f32 v149, v90, v91
v_cvt_pk_bf16_f32 v150, v92, v93
v_cvt_pk_bf16_f32 v151, v94, v95
s_cbranch_vccz GW_61_s
GW_61:
s_nop 0
v_mfma_f32_32x32x16_bf16 v[128:143], v[172:175], v[148:151], v[128:143]
s_cmp_eq_u32 s31, 3
s_cbranch_scc1 FIX_62_s
FIX_62:
v_mfma_f32_32x32x16_bf16 v[80:95], v[48:51], v[24:27], v[112:127]
s_mov_b64 exec, s[44:45]
ds_read_b128 v[168:171], v176 offset:18432
ds_read_b128 v[172:175], v176 offset:19456
s_mov_b64 exec, -1
v_exp_f32 v64, v64
v_exp_f32 v65, v65
v_exp_f32 v66, v66
v_exp_f32 v67, v67
buffer_load_dwordx4 v[240:243], v1, s[4:7], s35 offen offset:0 sc1
buffer_load_dwordx4 v[244:247], v1, s[4:7], s35 offen offset:1024 sc1
v_exp_f32 v68, v68
v_exp_f32 v69, v69
v_exp_f32 v70, v70
v_exp_f32 v71, v71
v_cvt_pk_bf16_f32 v144, v64, v65
v_cvt_pk_bf16_f32 v145, v66, v67
v_cvt_pk_bf16_f32 v146, v68, v69
v_cvt_pk_bf16_f32 v147, v70, v71
v_exp_f32 v72, v72
s_waitcnt lgkmcnt(2)
v_mfma_f32_32x32x16_bf16 v[128:143], v[160:163], v[144:147], v[128:143]
v_exp_f32 v73, v73
v_exp_f32 v74, v74
v_exp_f32 v75, v75
v_exp_f32 v76, v76
s_cbranch_vccz GW_63_s
GW_63:
v_exp_f32 v77, v77
v_exp_f32 v78, v78
v_exp_f32 v79, v79
v_cvt_pk_bf16_f32 v148, v72, v73
v_cvt_pk_bf16_f32 v149, v74, v75
v_cvt_pk_bf16_f32 v150, v76, v77
v_cvt_pk_bf16_f32 v151, v78, v79
s_mov_b64 exec, 0xffff
buffer_load_dword v181, v1, s[4:7], s3 offen sc1
s_mov_b64 exec, -1
v_mfma_f32_32x32x16_bf16 v[128:143], v[164:167], v[148:151], v[128:143]
s_cmp_eq_u32 s31, 4
s_cbranch_scc1 FIX_64_s
FIX_64:
v_mfma_f32_32x32x16_bf16 v[64:79], v[52:55], v[24:27], v[112:127]
s_mov_b64 exec, s[44:45]
ds_read_b128 v[160:163], v176 offset:14336
ds_read_b128 v[164:167], v176 offset:15360
s_mov_b64 exec, -1
v_exp_f32 v80, v80
v_exp_f32 v81, v81
v_exp_f32 v82, v82
v_exp_f32 v83, v83
buffer_load_dwordx4 v[248:251], v1, s[4:7], s35 offen offset:2048 sc1
buffer_load_dwordx4 v[252:255], v1, s[4:7], s35 offen offset:3072 sc1
v_exp_f32 v84, v84
v_exp_f32 v85, v85
v_exp_f32 v86, v86
v_exp_f32 v87, v87
v_cvt_pk_bf16_f32 v144, v80, v81
v_cvt_pk_bf16_f32 v145, v82, v83
v_cvt_pk_bf16_f32 v146, v84, v85
v_cvt_pk_bf16_f32 v147, v86, v87
v_exp_f32 v88, v88
s_waitcnt lgkmcnt(2)
v_mfma_f32_32x32x16_bf16 v[128:143], v[168:171], v[144:147], v[128:143]
v_exp_f32 v89, v89
v_exp_f32 v90, v90
v_exp_f32 v91, v91
v_exp_f32 v92, v92
s_cbranch_vccz GW_65_s
GW_65:
v_exp_f32 v93, v93
v_exp_f32 v94, v94
v_exp_f32 v95, v95
v_cvt_pk_bf16_f32 v148, v88, v89
v_cvt_pk_bf16_f32 v149, v90, v91
v_cvt_pk_bf16_f32 v150, v92, v93
v_cvt_pk_bf16_f32 v151, v94, v95
s_cbranch_vccz GW_66_s
GW_66:
s_nop 0
v_mfma_f32_32x32x16_bf16 v[128:143], v[172:175], v[148:151], v[128:143]
s_cmp_eq_u32 s31, 5
s_cbranch_scc1 FIX_67_s
FIX_67:
v_mfma_f32_32x32x16_bf16 v[80:95], v[56:59], v[24:27], v[112:127]
s_mov_b64 exec, s[44:45]
ds_read_b128 v[168:171], v176 offset:10240
ds_read_b128 v[172:175], v176 offset:11264
s_mov_b64 exec, -1
v_exp_f32 v64, v64
v_exp_f32 v65, v65
v_exp_f32 v66, v66
v_exp_f32 v67, v67
s_cbranch_vccz GW_68_s
GW_68:
v_exp_f32 v68, v68
v_exp_f32 v69, v69
v_exp_f32 v70, v70
v_exp_f32 v71, v71
v_cvt_pk_bf16_f32 v144, v64, v65
v_cvt_pk_bf16_f32 v145, v66, v67
v_cvt_pk_bf16_f32 v146, v68, v69
v_cvt_pk_bf16_f32 v147, v70, v71
v_exp_f32 v72, v72
s_waitcnt lgkmcnt(2)
v_mfma_f32_32x32x16_bf16 v[128:143], v[160:163], v[144:147], v[128:143]
v_exp_f32 v73, v73
v_exp_f32 v74, v74
v_exp_f32 v75, v75
v_exp_f32 v76, v76
s_cbranch_vccz GW_69_s
GW_69:
v_exp_f32 v77, v77
v_exp_f32 v78, v78
v_exp_f32 v79, v79
v_cvt_pk_bf16_f32 v148, v72, v73
v_cvt_pk_bf16_f32 v149, v74, v75
v_cvt_pk_bf16_f32 v150, v76, v77
v_cvt_pk_bf16_f32 v151, v78, v79
s_add_u32 s23, s55, 1
s_waitcnt vmcnt(2)
v_cmp_gt_u32 s[96:97], s23, v181
s_nop 0
s_and_b32 s96, s96, 0xffff
s_cbranch_scc1 AP_70_s
AP_70:
s_lshl_b32 s26, s16, 12
s_add_u32 s24, s26, s29
s_add_u32 s24, s24, s17
s_add_u32 s57, s24, 4194304
s_add_u32 s27, s26, 98304
s_add_u32 s58, s26, 147456
s_cmp_lt_u32 s16, 2
s_cselect_b32 s58, s27, s58
s_mov_b32 m0, s58
s_nop 0
buffer_load_dwordx4 v1, s[4:7], s57 offen offset:0 sc1 lds
buffer_load_dwordx4 v1, s[4:7], s57 offen offset:1024 sc1 lds
buffer_load_dwordx4 v1, s[4:7], s57 offen offset:2048 sc1 lds
buffer_load_dwordx4 v1, s[4:7], s57 offen offset:3072 sc1 lds
v_mfma_f32_32x32x16_bf16 v[128:143], v[164:167], v[148:151], v[128:143]
s_cmp_eq_u32 s31, 6
s_cbranch_scc1 FIX_71_s
FIX_71:
v_mfma_f32_32x32x16_bf16 v[64:79], v[60:63], v[24:27], v[112:127]
s_mov_b64 exec, s[44:45]
ds_read_b128 v[160:163], v176 offset:6144
ds_read_b128 v[164:167], v176 offset:7168
s_mov_b64 exec, -1
v_exp_f32 v80, v80
v_exp_f32 v81, v81
v_exp_f32 v82, v82
v_exp_f32 v83, v83
s_cbranch_vccz GW_72_s
GW_72:
v_exp_f32 v84, v84
v_exp_f32 v85, v85
v_exp_f32 v86, v86
v_exp_f32 v87, v87
v_cvt_pk_bf16_f32 v144, v80, v81
v_cvt_pk_bf16_f32 v145, v82, v83
v_cvt_pk_bf16_f32 v146, v84, v85
v_cvt_pk_bf16_f32 v147, v86, v87
v_exp_f32 v88, v88
s_waitcnt lgkmcnt(2)
v_mfma_f32_32x32x16_bf16 v[128:143], v[168:171], v[144:147], v[128:143]
v_exp_f32 v89, v89
v_exp_f32 v90, v90
v_exp_f32 v91, v91
v_exp_f32 v92, v92
v_exp_f32 v93, v93
v_exp_f32 v94, v94
v_exp_f32 v95, v95
v_cvt_pk_bf16_f32 v148, v88, v89
v_cvt_pk_bf16_f32 v149, v90, v91
v_cvt_pk_bf16_f32 v150, v92, v93
v_cvt_pk_bf16_f32 v151, v94, v95
s_nop 1
v_mfma_f32_32x32x16_bf16 v[128:143], v[172:175], v[148:151], v[128:143]
v_exp_f32 v64, v64
v_exp_f32 v65, v65
v_exp_f32 v66, v66
v_exp_f32 v67, v67
v_exp_f32 v68, v68
v_exp_f32 v69, v69
v_exp_f32 v70, v70
v_exp_f32 v71, v71
v_cvt_pk_bf16_f32 v144, v64, v65
v_cvt_pk_bf16_f32 v145, v66, v67
v_cvt_pk_bf16_f32 v146, v68, v69
v_cvt_pk_bf16_f32 v147, v70, v71
v_exp_f32 v72, v72
s_waitcnt lgkmcnt(0)
v_mfma_f32_32x32x16_bf16 v[128:143], v[160:163], v[144:147], v[128:143]
v_exp_f32 v73, v73
v_exp_f32 v74, v74
v_exp_f32 v75, v75
v_exp_f32 v76, v76
v_exp_f32 v77, v77
v_exp_f32 v78, v78
v_exp_f32 v79, v79
v_cvt_pk_bf16_f32 v148, v72, v73
v_cvt_pk_bf16_f32 v149, v74, v75
v_cvt_pk_bf16_f32 v150, v76, v77
v_cvt_pk_bf16_f32 v151, v78, v79
s_nop 1
v_mfma_f32_32x32x16_bf16 v[128:143], v[164:167], v[148:151], v[128:143]
s_lshl_b32 s24, s30, 15
s_add_u32 s24, s24, s41
s_lshl_b32 s26, s15, 1
s_add_u32 s26, s26, s42
s_lshl_b32 s26, s26, 9
s_add_u32 s24, s24, s26
s_add_u32 s24, s24, s17
s_add_u32 s59, s24, 4194304
s_nop 3
s_cmp_lg_u32 s42, 0
s_cbranch_scc1 K2H_73
v_rcp_f32 v182, v136
s_nop 0
v_pk_mul_f32 v[128:129], v[182:183], v[128:129] op_sel_hi:[0,1]
v_pk_mul_f32 v[130:131], v[182:183], v[130:131] op_sel_hi:[0,1]
v_pk_mul_f32 v[132:133], v[182:183], v[132:133] op_sel_hi:[0,1]
v_pk_mul_f32 v[134:135], v[182:183], v[134:135] op_sel_hi:[0,1]
s_branch K2H_74
K2H_73:
v_rcp_f32 v182, v128
s_nop 0
v_pk_mul_f32 v[128:129], v[182:183], v[136:137] op_sel_hi:[0,1]
v_pk_mul_f32 v[130:131], v[182:183], v[138:139] op_sel_hi:[0,1]
v_pk_mul_f32 v[132:133], v[182:183], v[140:141] op_sel_hi:[0,1]
v_pk_mul_f32 v[134:135], v[182:183], v[142:143] op_sel_hi:[0,1]
K2H_74:
v_cvt_pk_bf16_f32 v184, v128, v129
v_cvt_pk_bf16_f32 v185, v130, v131
v_cvt_pk_bf16_f32 v186, v132, v133
v_cvt_pk_bf16_f32 v187, v134, v135
buffer_store_dwordx4 v[184:187], v2, s[4:7], s59 offen sc1
s_and_b32 s30, s15, 3
s_lshl_b32 s30, s30, 2
s_add_u32 s30, s30, s16
s_lshl_b32 s31, s30, 10
s_add_u32 s31, s31, s29
s_add_u32 s24, s31, s20
s_add_u32 s24, s24, 16777216
buffer_load_dwordx4 v[100:103], v1, s[4:7], s24 offen sc1
s_add_u32 s24, s24, 65536
buffer_load_dwordx4 v[104:107], v1, s[4:7], s24 offen sc1
v_add_u32 v112, 98304, v1
v_and_b32 v109, 15, v0
v_lshlrev_b32 v109, 3, v109
v_lshrrev_b32 v110, 5, v0
v_lshl_add_u32 v109, v110, 2, v109
s_waitcnt vmcnt(3)
s_barrier
ds_read_b128 v[32:35], v112 offset:0
ds_read_b128 v[36:39], v112 offset:1024
ds_read_b128 v[40:43], v112 offset:2048
ds_read_b128 v[44:47], v112 offset:3072
ds_read_b128 v[48:51], v112 offset:4096
ds_read_b128 v[52:55], v112 offset:5120
s_add_u32 s24, s31, s17
s_add_u32 s60, s24, 6291456
s_lshr_b32 s25, s29, 3
s_lshl_b32 s26, s30, 7
s_add_u32 s25, s25, s26
s_add_u32 s25, s25, s17
s_add_u32 s61, s25, 8388608
s_waitcnt lgkmcnt(4)
v_mfma_f32_16x16x32_bf16 v[24:27], a[192:195], v[32:35], 0
v_mfma_f32_16x16x32_bf16 v[28:31], v[192:195], v[32:35], 0
ds_read_b128 v[56:59], v112 offset:6144
v_mfma_f32_16x16x32_bf16 v[24:27], a[196:199], v[36:39], v[24:27]
v_mfma_f32_16x16x32_bf16 v[28:31], v[196:199], v[36:39], v[28:31]
ds_read_b128 v[60:63], v112 offset:7168
s_waitcnt lgkmcnt(4)
v_mfma_f32_16x16x32_bf16 v[24:27], a[200:203], v[40:43], v[24:27]
v_mfma_f32_16x16x32_bf16 v[28:31], v[200:203], v[40:43], v[28:31]
ds_read_b128 v[64:67], v112 offset:57344
v_mfma_f32_16x16x32_bf16 v[24:27], a[204:207], v[44:47], v[24:27]
v_mfma_f32_16x16x32_bf16 v[28:31], v[204:207], v[44:47], v[28:31]
ds_read_b128 v[68:71], v112 offset:58368
s_waitcnt lgkmcnt(4)
v_mfma_f32_16x16x32_bf16 v[24:27], a[208:211], v[48:51], v[24:27]
v_mfma_f32_16x16x32_bf16 v[28:31], v[208:211], v[48:51], v[28:31]
ds_read_b128 v[72:75], v112 offset:59392
v_mfma_f32_16x16x32_bf16 v[24:27], a[212:215], v[52:55], v[24:27]
v_mfma_f32_16x16x32_bf16 v[28:31], v[212:215], v[52:55], v[28:31]
ds_read_b128 v[76:79], v112 offset:60416
s_waitcnt lgkmcnt(4)
v_mfma_f32_16x16x32_bf16 v[24:27], a[216:219], v[56:59], v[24:27]
v_mfma_f32_16x16x32_bf16 v[28:31], v[216:219], v[56:59], v[28:31]
ds_read_b128 v[80:83], v112 offset:61440
v_mfma_f32_16x16x32_bf16 v[24:27], a[220:223], v[60:63], v[24:27]
v_mfma_f32_16x16x32_bf16 v[28:31], v[220:223], v[60:63], v[28:31]
ds_read_b128 v[84:87], v112 offset:62464
s_waitcnt lgkmcnt(4)
v_mfma_f32_16x16x32_bf16 v[24:27], a[224:227], v[64:67], v[24:27]
v_mfma_f32_16x16x32_bf16 v[28:31], v[224:227], v[64:67], v[28:31]
ds_read_b128 v[88:91], v112 offset:63488
v_mfma_f32_16x16x32_bf16 v[24:27], a[228:231], v[68:71], v[24:27]
v_mfma_f32_16x16x32_bf16 v[28:31], v[228:231], v[68:71], v[28:31]
ds_read_b128 v[92:95], v112 offset:64512
s_waitcnt lgkmcnt(4)
v_mfma_f32_16x16x32_bf16 v[24:27], a[232:235], v[72:75], v[24:27]
v_mfma_f32_16x16x32_bf16 v[28:31], v[232:235], v[72:75], v[28:31]
v_mfma_f32_16x16x32_bf16 v[24:27], a[236:239], v[76:79], v[24:27]
v_mfma_f32_16x16x32_bf16 v[28:31], v[236:239], v[76:79], v[28:31]
s_waitcnt vmcnt(0)
s_waitcnt lgkmcnt(2)
v_mfma_f32_16x16x32_bf16 v[24:27], a[240:243], v[80:83], v[24:27]
v_mfma_f32_16x16x32_bf16 v[28:31], v[240:243], v[80:83], v[28:31]
v_lshlrev_b32 v32, 16, v100
v_and_b32 v33, 0xffff0000, v100
v_mfma_f32_16x16x32_bf16 v[24:27], a[244:247], v[84:87], v[24:27]
v_mfma_f32_16x16x32_bf16 v[28:31], v[244:247], v[84:87], v[28:31]
v_lshlrev_b32 v34, 16, v101
v_and_b32 v35, 0xffff0000, v101
s_waitcnt lgkmcnt(0)
v_mfma_f32_16x16x32_bf16 v[24:27], a[248:251], v[88:91], v[24:27]
v_mfma_f32_16x16x32_bf16 v[28:31], v[248:251], v[88:91], v[28:31]
v_lshlrev_b32 v36, 16, v102
v_and_b32 v37, 0xffff0000, v102
v_mfma_f32_16x16x32_bf16 v[24:27], a[252:255], v[92:95], v[24:27]
v_mfma_f32_16x16x32_bf16 v[28:31], v[252:255], v[92:95], v[28:31]
v_lshlrev_b32 v38, 16, v103
v_and_b32 v39, 0xffff0000, v103
s_nop 4
v_pk_add_f32 v[24:25], v[24:25], v[32:33]
v_pk_add_f32 v[26:27], v[26:27], v[34:35]
v_pk_add_f32 v[28:29], v[28:29], v[36:37]
v_pk_add_f32 v[30:31], v[30:31], v[38:39]
v_cvt_pk_bf16_f32 v96, v24, v25
v_cvt_pk_bf16_f32 v97, v26, v27
v_cvt_pk_bf16_f32 v98, v28, v29
v_cvt_pk_bf16_f32 v99, v30, v31
buffer_store_dwordx4 v[96:99], v1, s[4:7], s60 offen sc1
v_pk_add_f32 v[34:35], v[24:25], v[26:27]
v_pk_mul_f32 v[36:37], v[24:25], v[24:25]
v_pk_add_f32 v[32:33], v[28:29], v[30:31]
v_pk_fma_f32 v[36:37], v[26:27], v[26:27], v[36:37]
v_pk_fma_f32 v[36:37], v[28:29], v[28:29], v[36:37]
v_pk_fma_f32 v[36:37], v[30:31], v[30:31], v[36:37]
v_pk_add_f32 v[34:35], v[34:35], v[32:33]
v_add_f32 v33, v36, v37
v_add_f32 v32, v34, v35
s_nop 1
v_permlane32_swap_b32 v32, v33
v_add_f32 v32, v32, v33
v_mov_b32 v33, v32
s_nop 1
v_permlane16_swap_b32 v32, v33
v_add_f32 v32, v32, v33
buffer_store_dword v32, v109, s[4:7], s61 offen sc1
s_cmp_lg_u32 s18, 0
s_cbranch_scc1 GW_75
v_mfma_f32_32x32x16_bf16 a[128:143], a[120:123], a[144:147], a[128:143]
v_mfma_f32_32x32x16_bf16 a[128:143], a[124:127], a[144:147], a[128:143]
v_lshrrev_b32 v114, 5, v0
v_mul_u32_u24 v114, 96, v114
s_mul_i32 s24, s16, 192
s_add_u32 s24, s24, 147968
v_add_u32 v114, s24, v114
s_nop 6
ds_write_b128 v114, a[128:131] offset:0
ds_write_b128 v114, a[132:135] offset:16
ds_write_b128 v114, a[136:139] offset:32
ds_write_b128 v114, a[140:143] offset:48
s_waitcnt lgkmcnt(0)
s_add_u32 s39, s38, 0
buffer_load_dwordx4 a[128:131], v188, s[4:7], s39 offen offset:0 sc1
buffer_load_dwordx4 a[132:135], v188, s[4:7], s39 offen offset:2048 sc1
s_add_u32 s39, s38, 4096
buffer_load_dwordx4 a[136:139], v188, s[4:7], s39 offen offset:0 sc1
buffer_load_dwordx4 a[140:143], v188, s[4:7], s39 offen offset:2048 sc1
s_add_u32 s39, s38, 8192
buffer_load_dwordx4 a[144:147], v188, s[4:7], s39 offen offset:0 sc1
buffer_load_dwordx4 a[148:151], v188, s[4:7], s39 offen offset:2048 sc1
GW_75:
s_lshr_b32 s24, s16, 1
s_lshl_b32 s24, s24, 14
s_lshl_b32 s26, s42, 12
s_add_u32 s24, s24, s26
s_add_u32 s24, s24, s41
s_add_u32 s24, s24, s17
s_add_u32 s24, s24, 6291456
s_and_b32 s43, s15, 1
s_lshl_b32 s25, s43, 15
s_add_u32 s32, s24, s25
s_xor_b32 s25, s25, 32768
s_add_u32 s33, s24, s25
s_lshr_b32 s36, s41, 3
s_lshl_b32 s24, s16, 11
s_add_u32 s36, s36, s24
s_add_u32 s36, s36, s17
s_add_u32 s36, s36, 8388608
s_lshl_b32 s24, s15, 1
s_lshr_b32 s25, s16, 1
s_add_u32 s24, s24, s25
s_mul_i32 s24, s24, 6
s_mul_i32 s25, s14, 352256
s_add_u32 s25, s25, s17
s_add_u32 s25, s25, 9437184
s_lshl_b32 s26, s42, 2
s_add_u32 s26, s26, s24
s_lshl_b32 s37, s26, 8
s_add_u32 s37, s37, s25
s_cmp_lt_u32 s26, 172
s_cselect_b32 s37, s37, 0x40000000
s_mul_i32 s26, s43, 88064
s_sub_u32 s38, s37, s26
s_add_u32 s38, s38, 88064
s_add_u32 s37, s37, s26
s_add_u32 s26, s24, s42
s_add_u32 s26, s26, 2
s_lshl_b32 s39, s26, 8
s_add_u32 s39, s39, s25
s_cmp_lt_u32 s26, 172
s_cselect_b32 s39, s39, 0x40000000
s_and_b32 s40, s15, 7
s_mul_i32 s40, s40, 176128
s_mul_i32 s24, s16, 22528
s_add_u32 s40, s40, s24
s_add_u32 s40, s40, 6291456
s_add_u32 s56, s40, 88064
v_and_b32 v128, 15, v0
v_lshrrev_b32 v129, 4, v0
v_lshlrev_b32 v136, 9, v129
v_lshl_add_u32 v136, v128, 3, v136
s_lshl_b32 s24, s16, 8
s_add_u32 s24, s24, 149504
v_lshl_add_u32 v137, v128, 4, s24
v_and_b32 v130, 31, v0
s_lshl_b32 s24, s43, 9
s_add_u32 s25, s24, 149504
v_lshl_add_u32 v138, v130, 4, s25
v_xor_b32 v139, 512, v138
v_and_b32 v130, 1, v129
v_lshlrev_b32 v140, 13, v130
v_lshrrev_b32 v131, 5, v0
v_lshl_add_u32 v140, v131, 8, v140
v_lshl_add_u32 v140, v128, 4, v140
s_lshl_b32 s24, s42, 9
s_add_u32 s25, s24, 98304
s_sub_u32 s24, 98304, s24
v_add_u32 v141, s24, v140
v_add_u32 v140, s25, v140
s_lshl_b32 s24, s16, 11
s_add_u32 s24, s24, 155648
v_add_u32 v142, s24, v1
v_xor_b32 v143, 2048, v142
v_xor_b32 v113, s43, v131
v_lshl_add_u32 v113, v113, 1, v130
v_mul_u32_u24 v113, 44032, v113
v_lshl_add_u32 v113, v128, 4, v113
v_mul_u32_u24 v114, 96, v131
s_mul_i32 s24, s16, 192
s_add_u32 s24, s24, 147968
v_add_u32 v114, s24, v114
s_lshr_b32 s25, s15, 3
s_lshl_b32 s25, s25, 1
s_lshl_b32 s24, s14, 3
s_add_u32 s25, s25, s24
s_and_b32 s26, s15, 7
s_lshr_b32 s24, s16, 1
s_add_u32 s24, s24, s25
s_lshl_b32 s52, s24, 14
s_lshl_b32 s24, s42, 7
s_add_u32 s52, s52, s24
s_lshl_b32 s24, s26, 11
s_add_u32 s52, s52, s24
s_add_u32 s52, s52, s17
s_lshl_b32 s53, s25, 14
s_lshl_b32 s24, s16, 13
s_add_u32 s53, s53, s24
s_lshl_b32 s24, s26, 7
s_add_u32 s53, s53, s24
s_add_u32 s24, s52, 16777216
s_cmp_eq_u32 s18, 0
s_cselect_b32 s53, s24, s53
s_cselect_b64 vcc, -1, 0
s_cselect_b32 s68, s24, 0x40000000
s_cselect_b32 s64, s4, s12
s_cselect_b32 s65, s5, s13
s_cselect_b32 s66, s6, 0x200000
s_mov_b32 s67, 0x20000
s_lshl_b32 s54, s25, 10
s_lshl_b32 s24, s26, 8
s_add_u32 s54, s54, s24
s_lshl_b32 s24, s16, 6
s_add_u32 s54, s54, s24
s_add_u32 s54, s54, s17
s_add_u32 s54, s54, 18874368
s_add_u32 s52, s52, 6291456
v_and_b32 v9, 7, v0
v_lshrrev_b32 v10, 3, v0
v_lshlrev_b32 v4, 8, v10
v_lshl_add_u32 v4, v9, 4, v4
v_lshlrev_b32 v5, 10, v9
v_lshl_add_u32 v5, v10, 4, v5
v_cndmask_b32 v5, v5, v4, vcc
v_lshrrev_b32 v6, 4, v0
v_lshlrev_b32 v6, 13, v6
v_and_b32 v7, 1, v10
v_lshl_add_u32 v6, v7, 9, v6
v_lshl_add_u32 v6, v9, 4, v6
s_lshl_b32 s24, s16, 7
s_add_u32 s24, s24, 98304
v_add_u32 v6, s24, v6
v_lshrrev_b32 v7, 5, v0
v_lshlrev_b32 v7, 2, v7
v_lshl_add_u32 v7, v9, 3, v7
s_lshl_b32 s24, s16, 11
s_add_u32 s24, s24, 98304
v_add_u32 v8, s24, v1
s_lshl_b32 s24, s16, 13
s_add_u32 s24, s24, 98304
v_add_u32 v9, s24, v1
s_add_u32 s24, s27, 32768
v_add_u32 v10, s24, v1
s_waitcnt vmcnt(6)
s_cmp_eq_u32 s18, 0
s_cbranch_scc1 GW_78
s_waitcnt vmcnt(0)
GW_78:
s_cmp_eq_u32 s16, 3
s_barrier
s_cbranch_scc1 SIG_79_s
SIG_79:
buffer_load_dword v111, v2, s[4:7], s59 offen offset:0 sc1
buffer_load_dword v111, v1, s[4:7], s60 offen offset:0 sc1
buffer_load_dword v111, off, s[4:7], s61 sc1
s_cmp_lg_u32 s18, 0
s_cbranch_scc1 CS13_80
s_waitcnt vmcnt(3)
v_mov_b32 v24, s46
v_mov_b32 v25, s46
v_mov_b32 v26, s46
v_mov_b32 v27, s46
s_nop 1
v_mfma_f32_32x32x16_bf16 v[48:63], a[128:131], v[24:27], 0
v_mfma_f32_32x32x16_bf16 v[48:63], a[132:135], v[24:27], v[48:63]
v_mfma_f32_32x32x16_bf16 v[48:63], a[136:139], v[24:27], v[48:63]
v_mfma_f32_32x32x16_bf16 v[48:63], a[140:143], v[24:27], v[48:63]
v_mfma_f32_32x32x16_bf16 v[48:63], a[144:147], v[24:27], v[48:63]
v_mfma_f32_32x32x16_bf16 v[48:63], a[148:151], v[24:27], v[48:63]
v_mfma_f32_32x32x16_bf16 v[48:63], a[152:155], v[24:27], v[48:63]
v_mfma_f32_32x32x16_bf16 v[48:63], a[156:159], v[24:27], v[48:63]
v_mfma_f32_32x32x16_bf16 v[48:63], a[160:163], v[24:27], v[48:63]
v_mfma_f32_32x32x16_bf16 v[48:63], a[164:167], v[24:27], v[48:63]
v_mfma_f32_32x32x16_bf16 v[48:63], a[168:171], v[24:27], v[48:63]
v_mfma_f32_32x32x16_bf16 v[48:63], a[172:175], v[24:27], v[48:63]
v_mfma_f32_32x32x16_bf16 v[48:63], a[176:179], v[24:27], v[48:63]
v_mfma_f32_32x32x16_bf16 v[48:63], a[180:183], v[24:27], v[48:63]
v_mfma_f32_32x32x16_bf16 v[48:63], a[184:187], v[24:27], v[48:63]
v_mfma_f32_32x32x16_bf16 v[48:63], a[188:191], v[24:27], v[48:63]
s_xor_b32 s24, s16, 1
s_sub_u32 s24, s24, s16
s_mul_i32 s24, s24, 192
v_add_u32 v115, s24, v114
s_nop 7
ds_write_b128 v115, v[56:59] offset:64
ds_write_b128 v115, v[60:63] offset:80
s_waitcnt lgkmcnt(0)
s_barrier
ds_read_b128 v[56:59], v114 offset:64
ds_read_b128 v[60:63], v114 offset:80
s_waitcnt lgkmcnt(0)
v_add_f32 v48, v48, v56
v_add_f32 v49, v49, v57
v_add_f32 v50, v50, v58
v_add_f32 v51, v51, v59
v_add_f32 v52, v52, v60
v_add_f32 v53, v53, v61
v_add_f32 v54, v54, v62
v_add_f32 v55, v55, v63
ds_write_b128 v114, v[48:51] offset:64
ds_write_b128 v114, v[52:55] offset:80
CS13_80:
s_cmp_lg_u32 s16, 0
s_cbranch_scc1 P0_82
s_add_u32 s24, s22, 4096
s_add_u32 s23, s55, 2
POLL_84:
s_mov_b64 exec, 0xffff
buffer_load_dword v111, v1, s[4:7], s3 offen sc1
s_mov_b64 exec, -1
s_waitcnt vmcnt(0)
v_cmp_gt_u32 s[96:97], s23, v111
s_nop 0
s_and_b32 s96, s96, 0xffff
s_cbranch_scc0 PX_85
s_sub_u32 s21, s21, 1
s_cbranch_scc1 PX_85_t
s_and_b32 s96, s21, 15
s_cbranch_scc1 POLL_84
buffer_load_dword v111, off, s[4:7], s24 sc1
s_waitcnt vmcnt(0)
v_readfirstlane_b32 s96, v111
s_nop 0
s_cmp_lt_u32 s96, 16
s_cbranch_scc1 POLL_84
s_branch PX_85
PX_85_t:
s_mov_b32 s21, 0
PX_85:
P0_82:
s_barrier
s_add_u32 s57, s57, 65536
s_mov_b32 m0, s58
s_nop 0
buffer_load_dwordx4 v1, s[4:7], s57 offen offset:0 sc1 lds
buffer_load_dwordx4 v1, s[4:7], s57 offen offset:1024 sc1 lds
buffer_load_dwordx4 v1, s[4:7], s57 offen offset:2048 sc1 lds
buffer_load_dwordx4 v1, s[4:7], s57 offen offset:3072 sc1 lds
s_add_u32 m0, s27, 16384
s_nop 0
buffer_load_dwordx4 v1, s[4:7], s32 offen offset:0 sc1 lds
buffer_load_dwordx4 v1, s[4:7], s32 offen offset:1024 sc1 lds
buffer_load_dwordx4 v1, s[4:7], s32 offen offset:2048 sc1 lds
buffer_load_dwordx4 v1, s[4:7], s32 offen offset:3072 sc1 lds
buffer_load_dwordx2 v[128:129], v136, s[4:7], s36 offen offset:0 sc1
buffer_load_dwordx2 v[130:131], v136, s[4:7], s36 offen offset:128 sc1
buffer_load_dwordx2 v[132:133], v136, s[4:7], s36 offen offset:256 sc1
buffer_load_dwordx2 v[134:135], v136, s[4:7], s36 offen offset:384 sc1
s_add_u32 s24, s32, 8192
s_add_u32 m0, s27, 32768
s_nop 0
buffer_load_dwordx4 v1, s[4:7], s24 offen offset:0 sc1 lds
buffer_load_dwordx4 v1, s[4:7], s24 offen offset:1024 sc1 lds
buffer_load_dwordx4 v1, s[4:7], s24 offen offset:2048 sc1 lds
buffer_load_dwordx4 v1, s[4:7], s24 offen offset:3072 sc1 lds
s_waitcnt vmcnt(8)
s_barrier
ds_read_b128 v[32:35], v112 offset:0
ds_read_b128 v[36:39], v112 offset:1024
ds_read_b128 v[40:43], v112 offset:2048
ds_read_b128 v[44:47], v112 offset:3072
ds_read_b128 v[48:51], v112 offset:4096
ds_read_b128 v[52:55], v112 offset:5120
s_add_u32 s24, s31, s17
s_add_u32 s60, s24, 6356992
s_lshr_b32 s25, s29, 3
s_lshl_b32 s26, s30, 7
s_add_u32 s25, s25, s26
s_add_u32 s25, s25, s17
s_add_u32 s61, s25, 8396800
s_waitcnt lgkmcnt(4)
v_mfma_f32_16x16x32_bf16 v[24:27], a[192:195], v[32:35], 0
v_mfma_f32_16x16x32_bf16 v[28:31], v[192:195], v[32:35], 0
ds_read_b128 v[56:59], v112 offset:6144
v_mfma_f32_16x16x32_bf16 v[24:27], a[196:199], v[36:39], v[24:27]
v_mfma_f32_16x16x32_bf16 v[28:31], v[196:199], v[36:39], v[28:31]
ds_read_b128 v[60:63], v112 offset:7168
s_waitcnt lgkmcnt(4)
v_mfma_f32_16x16x32_bf16 v[24:27], a[200:203], v[40:43], v[24:27]
v_mfma_f32_16x16x32_bf16 v[28:31], v[200:203], v[40:43], v[28:31]
ds_read_b128 v[64:67], v112 offset:57344
v_mfma_f32_16x16x32_bf16 v[24:27], a[204:207], v[44:47], v[24:27]
v_mfma_f32_16x16x32_bf16 v[28:31], v[204:207], v[44:47], v[28:31]
ds_read_b128 v[68:71], v112 offset:58368
s_waitcnt lgkmcnt(4)
v_mfma_f32_16x16x32_bf16 v[24:27], a[208:211], v[48:51], v[24:27]
v_mfma_f32_16x16x32_bf16 v[28:31], v[208:211], v[48:51], v[28:31]
ds_read_b128 v[72:75], v112 offset:59392
v_mfma_f32_16x16x32_bf16 v[24:27], a[212:215], v[52:55], v[24:27]
v_mfma_f32_16x16x32_bf16 v[28:31], v[212:215], v[52:55], v[28:31]
ds_read_b128 v[76:79], v112 offset:60416
s_waitcnt lgkmcnt(4)
v_mfma_f32_16x16x32_bf16 v[24:27], a[216:219], v[56:59], v[24:27]
v_mfma_f32_16x16x32_bf16 v[28:31], v[216:219], v[56:59], v[28:31]
ds_read_b128 v[80:83], v112 offset:61440
v_mfma_f32_16x16x32_bf16 v[24:27], a[220:223], v[60:63], v[24:27]
v_mfma_f32_16x16x32_bf16 v[28:31], v[220:223], v[60:63], v[28:31]
ds_read_b128 v[84:87], v112 offset:62464
s_waitcnt lgkmcnt(4)
v_mfma_f32_16x16x32_bf16 v[24:27], a[224:227], v[64:67], v[24:27]
v_mfma_f32_16x16x32_bf16 v[28:31], v[224:227], v[64:67], v[28:31]
ds_read_b128 v[88:91], v112 offset:63488
v_mfma_f32_16x16x32_bf16 v[24:27], a[228:231], v[68:71], v[24:27]
v_mfma_f32_16x16x32_bf16 v[28:31], v[228:231], v[68:71], v[28:31]
ds_read_b128 v[92:95], v112 offset:64512
s_waitcnt lgkmcnt(4)
v_mfma_f32_16x16x32_bf16 v[24:27], a[232:235], v[72:75], v[24:27]
v_mfma_f32_16x16x32_bf16 v[28:31], v[232:235], v[72:75], v[28:31]
v_mfma_f32_16x16x32_bf16 v[24:27], a[236:239], v[76:79], v[24:27]
v_mfma_f32_16x16x32_bf16 v[28:31], v[236:239], v[76:79], v[28:31]
s_waitcnt lgkmcnt(2)
v_mfma_f32_16x16x32_bf16 v[24:27], a[240:243], v[80:83], v[24:27]
v_mfma_f32_16x16x32_bf16 v[28:31], v[240:243], v[80:83], v[28:31]
v_lshlrev_b32 v32, 16, v104
v_and_b32 v33, 0xffff0000, v104
v_mfma_f32_16x16x32_bf16 v[24:27], a[244:247], v[84:87], v[24:27]
v_mfma_f32_16x16x32_bf16 v[28:31], v[244:247], v[84:87], v[28:31]
v_lshlrev_b32 v34, 16, v105
v_and_b32 v35, 0xffff0000, v105
s_waitcnt lgkmcnt(0)
v_mfma_f32_16x16x32_bf16 v[24:27], a[248:251], v[88:91], v[24:27]
v_mfma_f32_16x16x32_bf16 v[28:31], v[248:251], v[88:91], v[28:31]
v_lshlrev_b32 v36, 16, v106
v_and_b32 v37, 0xffff0000, v106
v_mfma_f32_16x16x32_bf16 v[24:27], a[252:255], v[92:95], v[24:27]
v_mfma_f32_16x16x32_bf16 v[28:31], v[252:255], v[92:95], v[28:31]
v_lshlrev_b32 v38, 16, v107
v_and_b32 v39, 0xffff0000, v107
s_nop 4
v_pk_add_f32 v[24:25], v[24:25], v[32:33]
v_pk_add_f32 v[26:27], v[26:27], v[34:35]
v_pk_add_f32 v[28:29], v[28:29], v[36:37]
v_pk_add_f32 v[30:31], v[30:31], v[38:39]
v_cvt_pk_bf16_f32 v96, v24, v25
v_cvt_pk_bf16_f32 v97, v26, v27
v_cvt_pk_bf16_f32 v98, v28, v29
v_cvt_pk_bf16_f32 v99, v30, v31
buffer_store_dwordx4 v[96:99], v1, s[4:7], s60 offen sc1
v_pk_add_f32 v[34:35], v[24:25], v[26:27]
v_pk_mul_f32 v[36:37], v[24:25], v[24:25]
v_pk_add_f32 v[32:33], v[28:29], v[30:31]
v_pk_fma_f32 v[36:37], v[26:27], v[26:27], v[36:37]
v_pk_fma_f32 v[36:37], v[28:29], v[28:29], v[36:37]
v_pk_fma_f32 v[36:37], v[30:31], v[30:31], v[36:37]
v_pk_add_f32 v[34:35], v[34:35], v[32:33]
v_add_f32 v33, v36, v37
v_add_f32 v32, v34, v35
s_nop 1
v_permlane32_swap_b32 v32, v33
v_add_f32 v32, v32, v33
v_mov_b32 v33, v32
s_nop 1
v_permlane16_swap_b32 v32, v33
v_add_f32 v32, v32, v33
buffer_store_dword v32, v109, s[4:7], s61 offen sc1
v_mov_b32 v66, v113
ds_read_b128 v[12:15], v114 offset:0
ds_read_b128 v[16:19], v114 offset:16
ds_read_b128 v[20:23], v114 offset:32
ds_read_b128 v[24:27], v114 offset:48
ds_read_b128 v[28:31], v114 offset:64
ds_read_b128 v[32:35], v114 offset:80
ds_read_b128 v[104:107], v140 offset:16384
ds_read_b128 v[108:111], v141 offset:16896
ds_read_b128 v[112:115], v140 offset:17408
ds_read_b128 v[116:119], v141 offset:17920
ds_read_b128 v[120:123], v140 offset:18432
s_waitcnt lgkmcnt(3)
v_mfma_f32_32x32x16_bf16 v[72:87], a[0:3], v[104:107], 0
s_waitcnt vmcnt(2)
s_barrier
v_mfma_f32_32x32x16_bf16 v[72:87], a[4:7], v[108:111], v[72:87]
v_mfma_f32_32x32x16_bf16 v[88:103], a[128:131], v[104:107], 0
s_add_u32 m0, s27, 0
s_nop 0
buffer_load_dwordx4 v1, s[4:7], s33 offen offset:0 sc1 lds
s_waitcnt vmcnt(7)
v_add_f32 v128, v128, v130
v_add_f32 v129, v129, v131
ds_read_b128 v[124:127], v141 offset:18944
ds_read_b128 v[104:107], v140 offset:19456
s_waitcnt lgkmcnt(3)
v_mfma_f32_32x32x16_bf16 v[72:87], a[8:11], v[112:115], v[72:87]
v_add_f32 v132, v132, v134
v_add_f32 v133, v133, v135
buffer_load_dwordx4 v1, s[4:7], s33 offen offset:1024 sc1 lds
v_add_f32 v128, v128, v132
v_mfma_f32_32x32x16_bf16 v[88:103], a[132:135], v[112:115], v[88:103]
v_add_f32 v129, v129, v133
v_mov_b32 v130, v128
v_mov_b32 v131, v129
s_nop 0
ds_read_b128 v[108:111], v141 offset:19968
v_mfma_f32_32x32x16_bf16 v[72:87], a[12:15], v[116:119], v[72:87]
buffer_load_dwordx4 v1, s[4:7], s33 offen offset:2048 sc1 lds
v_permlane32_swap_b32 v128, v130
v_permlane32_swap_b32 v129, v131
v_add_f32 v128, v128, v130
ds_read_b128 v[112:115], v140 offset:20480
s_waitcnt lgkmcnt(3)
v_mfma_f32_32x32x16_bf16 v[72:87], a[16:19], v[120:123], v[72:87]
v_add_f32 v129, v129, v131
v_mov_b32 v130, v128
buffer_load_dwordx4 v1, s[4:7], s33 offen offset:3072 sc1 lds
v_mov_b32 v131, v129
v_mfma_f32_32x32x16_bf16 v[88:103], a[136:139], v[120:123], v[88:103]
s_nop 0
v_permlane16_swap_b32 v128, v130
v_permlane16_swap_b32 v129, v131
v_add_f32 v128, v128, v130
ds_read_b128 v[116:119], v141 offset:20992
v_mfma_f32_32x32x16_bf16 v[72:87], a[20:23], v[124:127], v[72:87]
buffer_load_dwordx4 a[192:195], v1, s[4:7], s40 offen offset:0 sc1
v_add_f32 v129, v129, v131
v_mul_f32 v128, 0x3b000000, v128
v_mul_f32 v130, 0x3b000000, v129
ds_read_b128 v[120:123], v140 offset:21504
s_waitcnt lgkmcnt(3)
v_mfma_f32_32x32x16_bf16 v[72:87], a[24:27], v[104:107], v[72:87]
v_fma_f32 v130, -v128, v128, v130
v_max_f32 v130, 0, v130
buffer_load_dwordx4 a[196:199], v1, s[4:7], s56 offen offset:0 sc1
v_add_f32 v130, 0x3727c5ac, v130
v_mfma_f32_32x32x16_bf16 v[88:103], a[140:143], v[104:107], v[88:103]
v_rsq_f32 v129, v130
s_nop 0
v_mul_f32 v129, 0xbfb8aa3b, v129
ds_read_b128 v[124:127], v141 offset:22016
v_mfma_f32_32x32x16_bf16 v[72:87], a[28:31], v[108:111], v[72:87]
ds_write_b128 v137, v[128:131] offset:0
buffer_load_dwordx4 a[200:203], v1, s[4:7], s40 offen offset:1024 sc1
s_nop 0
s_nop 0
ds_read_b128 v[104:107], v140 offset:22528
s_waitcnt lgkmcnt(4)
v_mfma_f32_32x32x16_bf16 v[72:87], a[32:35], v[112:115], v[72:87]
s_nop 0
s_nop 0
s_nop 0
buffer_load_dwordx4 a[204:207], v1, s[4:7], s56 offen offset:1024 sc1
v_mfma_f32_32x32x16_bf16 v[88:103], a[144:147], v[112:115], v[88:103]
s_nop 0
s_nop 0
s_nop 0
s_nop 0
ds_read_b128 v[108:111], v141 offset:23040
v_mfma_f32_32x32x16_bf16 v[72:87], a[36:39], v[116:119], v[72:87]
s_nop 0
buffer_load_dwordx4 a[208:211], v1, s[4:7], s40 offen offset:2048 sc1
s_nop 0
s_nop 0
ds_read_b128 v[112:115], v140 offset:23552
s_waitcnt lgkmcnt(4)
v_mfma_f32_32x32x16_bf16 v[72:87], a[40:43], v[120:123], v[72:87]
s_nop 0
s_nop 0
s_nop 0
buffer_load_dwordx4 a[212:215], v1, s[4:7], s56 offen offset:2048 sc1
v_mfma_f32_32x32x16_bf16 v[88:103], a[148:151], v[120:123], v[88:103]
s_nop 0
s_nop 0
s_nop 0
s_nop 0
ds_read_b128 v[116:119], v141 offset:24064
v_mfma_f32_32x32x16_bf16 v[72:87], a[44:47], v[124:127], v[72:87]
s_nop 0
buffer_load_dwordx4 a[216:219], v1, s[4:7], s40 offen offset:3072 sc1
s_nop 0
s_nop 0
ds_read_b128 v[120:123], v140 offset:32768
s_waitcnt lgkmcnt(3)
v_mfma_f32_32x32x16_bf16 v[72:87], a[48:51], v[104:107], v[72:87]
s_nop 0
s_nop 0
s_nop 0
s_add_u32 s40, s40, 4096
v_mfma_f32_32x32x16_bf16 v[88:103], a[152:155], v[104:107], v[88:103]
buffer_load_dwordx4 a[220:223], v1, s[4:7], s56 offen offset:3072 sc1
s_add_u32 s56, s56, 4096
s_nop 0
s_nop 0
ds_read_b128 v[124:127], v141 offset:33280
v_mfma_f32_32x32x16_bf16 v[72:87], a[52:55], v[108:111], v[72:87]
s_nop 0
s_nop 0
s_nop 0
ds_read_b128 v[104:107], v140 offset:33792
s_waitcnt lgkmcnt(3)
v_mfma_f32_32x32x16_bf16 v[72:87], a[56:59], v[112:115], v[72:87]
v_mfma_f32_32x32x16_bf16 v[88:103], a[156:159], v[112:115], v[88:103]
ds_read_b128 v[108:111], v141 offset:34304
v_mfma_f32_32x32x16_bf16 v[72:87], a[60:63], v[116:119], v[72:87]
ds_read_b128 v[112:115], v140 offset:34816
s_waitcnt lgkmcnt(3)
v_mfma_f32_32x32x16_bf16 v[72:87], a[64:67], v[120:123], v[72:87]
s_waitcnt vmcnt(8)
s_waitcnt lgkmcnt(9)
s_cmp_eq_u32 s16, 3
s_barrier
s_cbranch_scc1 SIG_86_s
SIG_86:
buffer_load_dword v67, v1, s[4:7], s60 offen offset:0 sc1
buffer_load_dword v67, off, s[4:7], s61 sc1
v_mfma_f32_32x32x16_bf16 v[72:87], a[68:71], v[124:127], v[72:87]
v_mfma_f32_32x32x16_bf16 v[88:103], a[160:163], v[120:123], v[88:103]
s_add_u32 s24, s33, 8192
s_add_u32 m0, s27, 16384
s_nop 0
buffer_load_dwordx4 v1, s[4:7], s24 offen offset:0 sc1 lds
s_nop 0
ds_read_b128 v[116:119], v141 offset:35328
ds_read_b128 v[120:123], v140 offset:35840
s_waitcnt lgkmcnt(3)
v_mfma_f32_32x32x16_bf16 v[72:87], a[72:75], v[104:107], v[72:87]
s_nop 0
s_nop 0
s_nop 0
s_nop 0
v_mfma_f32_32x32x16_bf16 v[88:103], a[164:167], v[104:107], v[88:103]
buffer_load_dwordx4 v1, s[4:7], s24 offen offset:1024 sc1 lds
s_nop 0
s_nop 0
s_nop 0
ds_read_b128 v[124:127], v141 offset:36352
v_mfma_f32_32x32x16_bf16 v[72:87], a[76:79], v[108:111], v[72:87]
s_nop 0
s_nop 0
buffer_load_dwordx4 v1, s[4:7], s24 offen offset:2048 sc1 lds
s_nop 0
ds_read_b128 v[104:107], v140 offset:36864
s_waitcnt lgkmcnt(3)
v_mfma_f32_32x32x16_bf16 v[72:87], a[80:83], v[112:115], v[72:87]
s_nop 0
s_nop 0
s_nop 0
s_nop 0
v_mfma_f32_32x32x16_bf16 v[88:103], a[168:171], v[112:115], v[88:103]
buffer_load_dwordx4 v1, s[4:7], s24 offen offset:3072 sc1 lds
s_nop 0
s_nop 0
s_nop 0
ds_read_b128 v[108:111], v141 offset:37376
v_mfma_f32_32x32x16_bf16 v[72:87], a[84:87], v[116:119], v[72:87]
s_nop 0
s_nop 0
buffer_load_dwordx4 a[224:227], v1, s[4:7], s40 offen offset:0 sc1
s_nop 0
ds_read_b128 v[112:115], v140 offset:37888
s_waitcnt lgkmcnt(3)
v_mfma_f32_32x32x16_bf16 v[72:87], a[88:91], v[120:123], v[72:87]
s_nop 0
s_nop 0
s_nop 0
s_nop 0
v_mfma_f32_32x32x16_bf16 v[88:103], a[172:175], v[120:123], v[88:103]
buffer_load_dwordx4 a[228:231], v1, s[4:7], s56 offen offset:0 sc1
s_nop 0
s_nop 0
s_nop 0
ds_read_b128 v[116:119], v141 offset:38400
v_mfma_f32_32x32x16_bf16 v[72:87], a[92:95], v[124:127], v[72:87]
s_nop 0
s_nop 0
buffer_load_dwordx4 a[232:235], v1, s[4:7], s40 offen offset:1024 sc1
s_nop 0
ds_read_b128 v[120:123], v140 offset:38912
s_waitcnt lgkmcnt(3)
v_mfma_f32_32x32x16_bf16 v[72:87], a[96:99], v[104:107], v[72:87]
s_nop 0
s_nop 0
s_nop 0
s_nop 0
v_mfma_f32_32x32x16_bf16 v[88:103], a[176:179], v[104:107], v[88:103]
buffer_load_dwordx4 a[236:239], v1, s[4:7], s56 offen offset:1024 sc1
s_nop 0
s_nop 0
s_nop 0
ds_read_b128 v[124:127], v141 offset:39424
v_mfma_f32_32x32x16_bf16 v[72:87], a[100:103], v[108:111], v[72:87]
s_nop 0
s_nop 0
buffer_load_dwordx4 a[240:243], v1, s[4:7], s40 offen offset:2048 sc1
s_nop 0
ds_read_b128 v[104:107], v140 offset:39936
s_waitcnt lgkmcnt(3)
v_mfma_f32_32x32x16_bf16 v[72:87], a[104:107], v[112:115], v[72:87]
s_nop 0
s_nop 0
s_nop 0
s_nop 0
v_mfma_f32_32x32x16_bf16 v[88:103], a[180:183], v[112:115], v[88:103]
buffer_load_dwordx4 a[244:247], v1, s[4:7], s56 offen offset:2048 sc1
s_nop 0
s_nop 0
s_nop 0
ds_read_b128 v[108:111], v141 offset:40448
v_mfma_f32_32x32x16_bf16 v[72:87], a[108:111], v[116:119], v[72:87]
s_nop 0
s_nop 0
buffer_load_dwordx4 a[248:251], v1, s[4:7], s40 offen offset:3072 sc1
s_nop 0
ds_read_b128 v[112:115], v140 offset:0
s_waitcnt lgkmcnt(3)
v_mfma_f32_32x32x16_bf16 v[72:87], a[112:115], v[120:123], v[72:87]
s_nop 0
s_nop 0
s_nop 0
s_nop 0
v_mfma_f32_32x32x16_bf16 v[88:103], a[184:187], v[120:123], v[88:103]
s_add_u32 s40, s40, 4096
buffer_load_dwordx4 a[252:255], v1, s[4:7], s56 offen offset:3072 sc1
s_add_u32 s56, s56, 4096
s_nop 0
ds_read_b128 v[116:119], v141 offset:512
v_mfma_f32_32x32x16_bf16 v[72:87], a[116:119], v[124:127], v[72:87]
s_nop 0
s_nop 0
s_nop 0
s_nop 0
ds_read_b128 v[120:123], v140 offset:1024
s_waitcnt lgkmcnt(3)
v_mfma_f32_32x32x16_bf16 v[72:87], a[120:123], v[104:107], v[72:87]
v_mfma_f32_32x32x16_bf16 v[88:103], a[188:191], v[104:107], v[88:103]
ds_read_b128 v[124:127], v141 offset:1536
v_mfma_f32_32x32x16_bf16 v[72:87], a[124:127], v[108:111], v[72:87]
ds_read_b128 v[104:107], v140 offset:2048
ds_read_b128 v[60:63], v138 offset:0
s_waitcnt lgkmcnt(4)
v_mfma_f32_32x32x16_bf16 v[36:51], a[0:3], v[112:115], 0
s_waitcnt vmcnt(8)
s_barrier
v_mfma_f32_32x32x16_bf16 v[36:51], a[4:7], v[116:119], v[36:51]
s_nop 2
ds_write_b128 v142, v[96:99]
ds_write_b128 v142, v[100:103] offset:1024
s_waitcnt lgkmcnt(2)
v_fma_f32 v52, -v60, v28, v88
v_fma_f32 v53, -v60, v29, v89
v_fma_f32 v54, -v60, v30, v90
v_fma_f32 v55, -v60, v31, v91
v_fma_f32 v56, -v60, v32, v92
v_fma_f32 v57, -v60, v33, v93
v_fma_f32 v58, -v60, v34, v94
v_fma_f32 v59, -v60, v35, v95
v_mfma_f32_32x32x16_bf16 v[88:103], a[128:131], v[112:115], 0
s_mov_b64 exec, 0xffff
buffer_load_dword v67, v1, s[4:7], s3 offen sc1
s_mov_b64 exec, -1
v_fma_f32 v72, -v60, v12, v72
v_fma_f32 v73, -v60, v13, v73
v_fma_f32 v76, -v60, v16, v76
ds_read_b128 v[108:111], v141 offset:2560
ds_read_b128 v[112:115], v140 offset:3072
s_waitcnt lgkmcnt(6)
v_mfma_f32_32x32x16_bf16 v[36:51], a[8:11], v[120:123], v[36:51]
v_fma_f32 v77, -v60, v17, v77
v_mul_f32 v64, v61, v72
buffer_load_dwordx4 v[144:147], v1, s[4:7], s40 offen offset:0 sc1
v_mul_f32 v65, v61, v73
v_mfma_f32_32x32x16_bf16 v[88:103], a[132:135], v[120:123], v[88:103]
v_exp_f32 v64, v64
v_exp_f32 v65, v65
ds_read_b128 v[116:119], v141 offset:3584
v_mfma_f32_32x32x16_bf16 v[36:51], a[12:15], v[124:127], v[36:51]
v_mul_f32 v72, v72, v76
v_mul_f32 v73, v73, v77
buffer_load_dwordx4 v[148:151], v1, s[4:7], s56 offen offset:0 sc1
v_fma_f32 v64, v64, v62, v62
ds_read_b128 v[120:123], v140 offset:4096
s_waitcnt lgkmcnt(3)
v_mfma_f32_32x32x16_bf16 v[36:51], a[16:19], v[104:107], v[36:51]
v_fma_f32 v65, v65, v62, v62
v_rcp_f32 v64, v64
v_rcp_f32 v65, v65
v_mfma_f32_32x32x16_bf16 v[88:103], a[136:139], v[104:107], v[88:103]
v_fma_f32 v74, -v60, v14, v74
v_fma_f32 v75, -v60, v15, v75
v_fma_f32 v78, -v60, v18, v78
v_fma_f32 v79, -v60, v19, v79
ds_read_b128 v[124:127], v141 offset:4608
v_mfma_f32_32x32x16_bf16 v[36:51], a[20:23], v[108:111], v[36:51]
v_mul_f32 v72, v72, v64
v_mul_f32 v73, v73, v65
v_cvt_pk_bf16_f32 v72, v72, v73
v_mul_f32 v64, v61, v74
ds_read_b128 v[104:107], v140 offset:5120
s_waitcnt lgkmcnt(3)
v_mfma_f32_32x32x16_bf16 v[36:51], a[24:27], v[112:115], v[36:51]
v_mul_f32 v65, v61, v75
v_exp_f32 v64, v64
v_exp_f32 v65, v65
v_mfma_f32_32x32x16_bf16 v[88:103], a[140:143], v[112:115], v[88:103]
v_mul_f32 v74, v74, v78
v_mul_f32 v75, v75, v79
v_fma_f32 v64, v64, v62, v62
v_fma_f32 v65, v65, v62, v62
ds_read_b128 v[108:111], v141 offset:5632
v_mfma_f32_32x32x16_bf16 v[36:51], a[28:31], v[116:119], v[36:51]
v_rcp_f32 v64, v64
v_rcp_f32 v65, v65
ds_read_b128 v[112:115], v140 offset:6144
v_fma_f32 v80, -v60, v20, v80
s_add_u32 s23, s55, 3
s_waitcnt vmcnt(2)
v_cmp_gt_u32 s[96:97], s23, v67
s_nop 0
s_and_b32 s96, s96, 0xffff
s_cbranch_scc1 AP_87_s
AP_87:
s_waitcnt lgkmcnt(3)
v_mfma_f32_32x32x16_bf16 v[36:51], a[32:35], v[120:123], v[36:51]
s_add_u32 s32, s32, 65536
s_add_u32 s33, s33, 65536
s_add_u32 m0, s27, 32768
s_nop 0
buffer_load_dwordx4 v1, s[4:7], s32 offen offset:0 sc1 lds
v_mfma_f32_32x32x16_bf16 v[88:103], a[144:147], v[120:123], v[88:103]
v_fma_f32 v81, -v60, v21, v81
v_fma_f32 v84, -v60, v24, v84
v_fma_f32 v85, -v60, v25, v85
v_mul_f32 v74, v74, v64
ds_read_b128 v[116:119], v141 offset:6656
v_mfma_f32_32x32x16_bf16 v[36:51], a[36:39], v[124:127], v[36:51]
buffer_load_dwordx4 v1, s[4:7], s32 offen offset:1024 sc1 lds
v_mul_f32 v75, v75, v65
v_cvt_pk_bf16_f32 v73, v74, v75
v_mul_f32 v64, v61, v80
ds_read_b128 v[120:123], v140 offset:7168
s_waitcnt lgkmcnt(3)
v_mfma_f32_32x32x16_bf16 v[36:51], a[40:43], v[104:107], v[36:51]
v_mul_f32 v65, v61, v81
buffer_load_dwordx4 v1, s[4:7], s32 offen offset:2048 sc1 lds
v_exp_f32 v64, v64
v_mfma_f32_32x32x16_bf16 v[88:103], a[148:151], v[104:107], v[88:103]
v_exp_f32 v65, v65
v_mul_f32 v80, v80, v84
v_mul_f32 v81, v81, v85
ds_read_b128 v[124:127], v141 offset:7680
v_mfma_f32_32x32x16_bf16 v[36:51], a[44:47], v[108:111], v[36:51]
buffer_load_dwordx4 v1, s[4:7], s32 offen offset:3072 sc1 lds
v_fma_f32 v64, v64, v62, v62
v_fma_f32 v65, v65, v62, v62
v_rcp_f32 v64, v64
ds_read_b128 v[104:107], v140 offset:16384
s_waitcnt lgkmcnt(3)
v_mfma_f32_32x32x16_bf16 v[36:51], a[48:51], v[112:115], v[36:51]
v_rcp_f32 v65, v65
s_add_u32 s36, s36, 8192
buffer_load_dwordx2 v[128:129], v136, s[4:7], s36 offen offset:0 sc1
v_mfma_f32_32x32x16_bf16 v[88:103], a[152:155], v[112:115], v[88:103]
v_fma_f32 v82, -v60, v22, v82
v_fma_f32 v83, -v60, v23, v83
v_fma_f32 v86, -v60, v26, v86
v_fma_f32 v87, -v60, v27, v87
ds_read_b128 v[108:111], v141 offset:16896
v_mfma_f32_32x32x16_bf16 v[36:51], a[52:55], v[116:119], v[36:51]
buffer_load_dwordx2 v[130:131], v136, s[4:7], s36 offen offset:128 sc1
v_mul_f32 v80, v80, v64
v_mul_f32 v81, v81, v65
v_cvt_pk_bf16_f32 v74, v80, v81
ds_read_b128 v[112:115], v140 offset:17408
s_waitcnt lgkmcnt(3)
v_mfma_f32_32x32x16_bf16 v[36:51], a[56:59], v[120:123], v[36:51]
v_mul_f32 v64, v61, v82
buffer_load_dwordx2 v[132:133], v136, s[4:7], s36 offen offset:256 sc1
v_mul_f32 v65, v61, v83
v_exp_f32 v64, v64
v_mfma_f32_32x32x16_bf16 v[88:103], a[156:159], v[120:123], v[88:103]
v_exp_f32 v65, v65
v_mul_f32 v82, v82, v86
buffer_load_dwordx2 v[134:135], v136, s[4:7], s36 offen offset:384 sc1
ds_read_b128 v[116:119], v141 offset:17920
v_mfma_f32_32x32x16_bf16 v[36:51], a[60:63], v[124:127], v[36:51]
v_mul_f32 v83, v83, v87
v_fma_f32 v64, v64, v62, v62
v_fma_f32 v65, v65, v62, v62
v_rcp_f32 v64, v64
ds_read_b128 v[120:123], v140 offset:18432
v_rcp_f32 v65, v65
v_mul_f32 v82, v82, v64
v_mul_f32 v83, v83, v65
v_cvt_pk_bf16_f32 v75, v82, v83
buffer_store_dwordx4 v[72:75], v3, s[4:7], s37 offen sc1
s_waitcnt lgkmcnt(3)
v_mfma_f32_32x32x16_bf16 v[36:51], a[64:67], v[104:107], v[36:51]
s_waitcnt lgkmcnt(15)
s_barrier
v_mfma_f32_32x32x16_bf16 v[36:51], a[68:71], v[108:111], v[36:51]
v_mfma_f32_32x32x16_bf16 v[88:103], a[160:163], v[104:107], v[88:103]
ds_read_b128 v[80:83], v143
ds_read_b128 v[84:87], v143 offset:1024
s_add_u32 s24, s32, 8192
s_add_u32 m0, s27, 0
ds_read_b128 v[124:127], v141 offset:18944
ds_read_b128 v[104:107], v140 offset:19456
s_waitcnt lgkmcnt(5)
v_mfma_f32_32x32x16_bf16 v[36:51], a[72:75], v[112:115], v[36:51]
buffer_load_dwordx4 v1, s[4:7], s24 offen offset:0 sc1 lds
buffer_load_dwordx4 v1, s[4:7], s24 offen offset:1024 sc1 lds
buffer_load_dwordx4 v1, s[4:7], s24 offen offset:2048 sc1 lds
s_waitcnt lgkmcnt(2)
v_add_f32 v52, v52, v80
v_mfma_f32_32x32x16_bf16 v[88:103], a[164:167], v[112:115], v[88:103]
v_add_f32 v53, v53, v81
v_add_f32 v54, v54, v82
v_add_f32 v55, v55, v83
buffer_load_dwordx4 v1, s[4:7], s24 offen offset:3072 sc1 lds
ds_read_b128 v[108:111], v141 offset:19968
v_mfma_f32_32x32x16_bf16 v[36:51], a[76:79], v[116:119], v[36:51]
v_add_f32 v56, v56, v84
v_add_f32 v57, v57, v85
v_add_f32 v58, v58, v86
v_add_f32 v59, v59, v87
ds_read_b128 v[112:115], v140 offset:20480
s_waitcnt lgkmcnt(3)
v_mfma_f32_32x32x16_bf16 v[36:51], a[80:83], v[120:123], v[36:51]
v_mul_f32 v64, v61, v52
buffer_load_dwordx4 v[152:155], v1, s[4:7], s40 offen offset:1024 sc1
v_mul_f32 v65, v61, v53
v_exp_f32 v64, v64
v_mfma_f32_32x32x16_bf16 v[88:103], a[168:171], v[120:123], v[88:103]
v_exp_f32 v65, v65
v_mul_f32 v52, v52, v56
v_mul_f32 v53, v53, v57
ds_read_b128 v[116:119], v141 offset:20992
v_mfma_f32_32x32x16_bf16 v[36:51], a[84:87], v[124:127], v[36:51]
buffer_load_dwordx4 v[156:159], v1, s[4:7], s56 offen offset:1024 sc1
v_fma_f32 v64, v64, v62, v62
v_fma_f32 v65, v65, v62, v62
v_rcp_f32 v64, v64
ds_read_b128 v[120:123], v140 offset:21504
s_waitcnt lgkmcnt(3)
v_mfma_f32_32x32x16_bf16 v[36:51], a[88:91], v[104:107], v[36:51]
v_rcp_f32 v65, v65
s_nop 0
buffer_load_dwordx4 v[160:163], v1, s[4:7], s40 offen offset:2048 sc1
v_mfma_f32_32x32x16_bf16 v[88:103], a[172:175], v[104:107], v[88:103]
v_mul_f32 v52, v52, v64
v_mul_f32 v53, v53, v65
v_cvt_pk_bf16_f32 v68, v52, v53
v_mul_f32 v64, v61, v54
ds_read_b128 v[124:127], v141 offset:22016
v_mfma_f32_32x32x16_bf16 v[36:51], a[92:95], v[108:111], v[36:51]
v_mul_f32 v65, v61, v55
buffer_load_dwordx4 v[164:167], v1, s[4:7], s56 offen offset:2048 sc1
v_exp_f32 v64, v64
ds_read_b128 v[104:107], v140 offset:22528
s_waitcnt lgkmcnt(3)
v_mfma_f32_32x32x16_bf16 v[36:51], a[96:99], v[112:115], v[36:51]
v_exp_f32 v65, v65
v_mul_f32 v54, v54, v58
v_mul_f32 v55, v55, v59
v_mfma_f32_32x32x16_bf16 v[88:103], a[176:179], v[112:115], v[88:103]
v_fma_f32 v64, v64, v62, v62
buffer_load_dwordx4 v[168:171], v1, s[4:7], s40 offen offset:3072 sc1
v_fma_f32 v65, v65, v62, v62
v_rcp_f32 v64, v64
ds_read_b128 v[108:111], v141 offset:23040
v_mfma_f32_32x32x16_bf16 v[36:51], a[100:103], v[116:119], v[36:51]
ds_read_b128 v[112:115], v140 offset:23552
s_waitcnt vmcnt(14)
s_barrier
s_waitcnt lgkmcnt(3)
v_mfma_f32_32x32x16_bf16 v[36:51], a[104:107], v[120:123], v[36:51]
v_rcp_f32 v65, v65
s_nop 0
v_mul_f32 v54, v54, v64
v_mfma_f32_32x32x16_bf16 v[88:103], a[180:183], v[120:123], v[88:103]
s_add_u32 s40, s40, 4096
buffer_load_dwordx4 v[172:175], v1, s[4:7], s56 offen offset:3072 sc1
s_add_u32 s56, s56, 4096
v_mul_f32 v55, v55, v65
ds_read_b128 v[116:119], v141 offset:24064
v_mfma_f32_32x32x16_bf16 v[36:51], a[108:111], v[124:127], v[36:51]
v_cvt_pk_bf16_f32 v69, v54, v55
s_waitcnt vmcnt(11)
v_add_f32 v128, v128, v130
v_add_f32 v129, v129, v131
v_add_f32 v132, v132, v134
ds_read_b128 v[120:123], v140 offset:32768
s_waitcnt lgkmcnt(3)
v_mfma_f32_32x32x16_bf16 v[36:51], a[112:115], v[104:107], v[36:51]
v_add_f32 v133, v133, v135
v_add_f32 v128, v128, v132
v_add_f32 v129, v129, v133
v_mov_b32 v130, v128
v_mfma_f32_32x32x16_bf16 v[88:103], a[184:187], v[104:107], v[88:103]
v_mov_b32 v131, v129
s_nop 0
v_permlane32_swap_b32 v128, v130
v_permlane32_swap_b32 v129, v131
ds_read_b128 v[124:127], v141 offset:33280
v_mfma_f32_32x32x16_bf16 v[36:51], a[116:119], v[108:111], v[36:51]
v_add_f32 v128, v128, v130
v_add_f32 v129, v129, v131
v_mov_b32 v130, v128
v_mov_b32 v131, v129
ds_read_b128 v[104:107], v140 offset:33792
s_waitcnt lgkmcnt(3)
v_mfma_f32_32x32x16_bf16 v[36:51], a[120:123], v[112:115], v[36:51]
s_nop 0
v_permlane16_swap_b32 v128, v130
v_permlane16_swap_b32 v129, v131
v_add_f32 v128, v128, v130
v_mfma_f32_32x32x16_bf16 v[88:103], a[188:191], v[112:115], v[88:103]
v_add_f32 v129, v129, v131
v_mul_f32 v128, 0x3b000000, v128
v_mul_f32 v130, 0x3b000000, v129
v_fma_f32 v130, -v128, v128, v130
ds_read_b128 v[108:111], v141 offset:34304
v_mfma_f32_32x32x16_bf16 v[36:51], a[124:127], v[116:119], v[36:51]
v_max_f32 v130, 0, v130
v_add_f32 v130, 0x3727c5ac, v130
v_rsq_f32 v129, v130
ds_read_b128 v[112:115], v140 offset:34816
s_nop 0
v_mul_f32 v129, 0xbfb8aa3b, v129
ds_write_b128 v137, v[128:131] offset:1024
ds_read_b128 v[60:63], v139 offset:0
s_waitcnt lgkmcnt(5)
v_mfma_f32_32x32x16_bf16 v[72:87], a[0:3], v[120:123], 0
s_waitcnt vmcnt(6)
s_barrier
v_mfma_f32_32x32x16_bf16 v[72:87], a[4:7], v[124:127], v[72:87]
ds_write_b128 v142, v[96:99]
ds_write_b128 v142, v[100:103] offset:1024
s_waitcnt lgkmcnt(2)
v_fma_f32 v52, -v60, v28, v88
v_fma_f32 v53, -v60, v29, v89
v_fma_f32 v54, -v60, v30, v90
v_fma_f32 v55, -v60, v31, v91
v_fma_f32 v56, -v60, v32, v92
v_fma_f32 v57, -v60, v33, v93
v_fma_f32 v58, -v60, v34, v94
v_fma_f32 v59, -v60, v35, v95
v_mfma_f32_32x32x16_bf16 v[88:103], a[128:131], v[120:123], 0
s_add_u32 m0, s27, 16384
s_nop 0
buffer_load_dwordx4 v1, s[4:7], s33 offen offset:0 sc1 lds
v_fma_f32 v36, -v60, v12, v36
v_fma_f32 v37, -v60, v13, v37
ds_read_b128 v[116:119], v141 offset:35328
ds_read_b128 v[120:123], v140 offset:35840
s_waitcnt lgkmcnt(7)
v_mfma_f32_32x32x16_bf16 v[72:87], a[8:11], v[104:107], v[72:87]
v_fma_f32 v40, -v60, v16, v40
v_fma_f32 v41, -v60, v17, v41
v_mul_f32 v64, v61, v36
buffer_load_dwordx4 v1, s[4:7], s33 offen offset:1024 sc1 lds
v_mfma_f32_32x32x16_bf16 v[88:103], a[132:135], v[104:107], v[88:103]
v_mul_f32 v65, v61, v37
v_exp_f32 v64, v64
v_exp_f32 v65, v65
ds_read_b128 v[124:127], v141 offset:36352
v_mfma_f32_32x32x16_bf16 v[72:87], a[12:15], v[108:111], v[72:87]
v_mul_f32 v36, v36, v40
v_mul_f32 v37, v37, v41
buffer_load_dwordx4 v1, s[4:7], s33 offen offset:2048 sc1 lds
v_fma_f32 v64, v64, v62, v62
ds_read_b128 v[104:107], v140 offset:36864
s_waitcnt lgkmcnt(3)
v_mfma_f32_32x32x16_bf16 v[72:87], a[16:19], v[112:115], v[72:87]
v_fma_f32 v65, v65, v62, v62
v_rcp_f32 v64, v64
v_rcp_f32 v65, v65
v_mfma_f32_32x32x16_bf16 v[88:103], a[136:139], v[112:115], v[88:103]
v_fma_f32 v38, -v60, v14, v38
buffer_load_dwordx4 v1, s[4:7], s33 offen offset:3072 sc1 lds
v_fma_f32 v39, -v60, v15, v39
v_fma_f32 v42, -v60, v18, v42
ds_read_b128 v[108:111], v141 offset:37376
v_mfma_f32_32x32x16_bf16 v[72:87], a[20:23], v[116:119], v[72:87]
v_fma_f32 v43, -v60, v19, v43
v_mul_f32 v36, v36, v64
v_mul_f32 v37, v37, v65
buffer_load_dwordx4 v[176:179], v1, s[4:7], s40 offen offset:0 sc1
ds_read_b128 v[112:115], v140 offset:37888
s_waitcnt lgkmcnt(3)
v_mfma_f32_32x32x16_bf16 v[72:87], a[24:27], v[120:123], v[72:87]
v_cvt_pk_bf16_f32 v36, v36, v37
v_mul_f32 v64, v61, v38
v_mul_f32 v65, v61, v39
v_exp_f32 v64, v64
v_mfma_f32_32x32x16_bf16 v[88:103], a[140:143], v[120:123], v[88:103]
v_exp_f32 v65, v65
buffer_load_dwordx4 v[180:183], v1, s[4:7], s56 offen offset:0 sc1
v_mul_f32 v38, v38, v42
ds_read_b128 v[116:119], v141 offset:38400
v_mfma_f32_32x32x16_bf16 v[72:87], a[28:31], v[124:127], v[72:87]
v_mul_f32 v39, v39, v43
v_fma_f32 v64, v64, v62, v62
v_fma_f32 v65, v65, v62, v62
v_rcp_f32 v64, v64
ds_read_b128 v[120:123], v140 offset:38912
s_waitcnt lgkmcnt(3)
v_mfma_f32_32x32x16_bf16 v[72:87], a[32:35], v[104:107], v[72:87]
buffer_load_dwordx4 v[184:187], v1, s[4:7], s40 offen offset:1024 sc1
v_rcp_f32 v65, v65
v_fma_f32 v44, -v60, v20, v44
v_mfma_f32_32x32x16_bf16 v[88:103], a[144:147], v[104:107], v[88:103]
v_fma_f32 v45, -v60, v21, v45
v_fma_f32 v48, -v60, v24, v48
v_fma_f32 v49, -v60, v25, v49
buffer_load_dwordx4 v[188:191], v1, s[4:7], s56 offen offset:1024 sc1
ds_read_b128 v[124:127], v141 offset:39424
v_mfma_f32_32x32x16_bf16 v[72:87], a[36:39], v[108:111], v[72:87]
v_mul_f32 v38, v38, v64
v_mul_f32 v39, v39, v65
v_cvt_pk_bf16_f32 v37, v38, v39
v_mul_f32 v64, v61, v44
ds_read_b128 v[104:107], v140 offset:39936
s_waitcnt lgkmcnt(3)
v_mfma_f32_32x32x16_bf16 v[72:87], a[40:43], v[112:115], v[72:87]
v_mul_f32 v65, v61, v45
buffer_load_dwordx4 v[192:195], v1, s[4:7], s40 offen offset:2048 sc1
v_exp_f32 v64, v64
v_mfma_f32_32x32x16_bf16 v[88:103], a[148:151], v[112:115], v[88:103]
v_exp_f32 v65, v65
v_mul_f32 v44, v44, v48
v_mul_f32 v45, v45, v49
ds_read_b128 v[108:111], v141 offset:40448
v_mfma_f32_32x32x16_bf16 v[72:87], a[44:47], v[116:119], v[72:87]
v_fma_f32 v64, v64, v62, v62
v_fma_f32 v65, v65, v62, v62
v_rcp_f32 v64, v64
ds_read_b128 v[112:115], v140 offset:0
s_waitcnt lgkmcnt(3)
v_mfma_f32_32x32x16_bf16 v[72:87], a[48:51], v[120:123], v[72:87]
v_rcp_f32 v65, v65
v_fma_f32 v46, -v60, v22, v46
v_fma_f32 v47, -v60, v23, v47
v_mfma_f32_32x32x16_bf16 v[88:103], a[152:155], v[120:123], v[88:103]
v_fma_f32 v50, -v60, v26, v50
v_fma_f32 v51, -v60, v27, v51
v_mul_f32 v44, v44, v64
v_mul_f32 v45, v45, v65
ds_read_b128 v[116:119], v141 offset:512
v_mfma_f32_32x32x16_bf16 v[72:87], a[52:55], v[124:127], v[72:87]
v_cvt_pk_bf16_f32 v38, v44, v45
v_mul_f32 v64, v61, v46
v_mul_f32 v65, v61, v47
v_exp_f32 v64, v64
ds_read_b128 v[120:123], v140 offset:1024
s_waitcnt lgkmcnt(3)
v_mfma_f32_32x32x16_bf16 v[72:87], a[56:59], v[104:107], v[72:87]
v_exp_f32 v65, v65
v_mul_f32 v46, v46, v50
v_mul_f32 v47, v47, v51
v_mfma_f32_32x32x16_bf16 v[88:103], a[156:159], v[104:107], v[88:103]
v_fma_f32 v64, v64, v62, v62
v_fma_f32 v65, v65, v62, v62
v_rcp_f32 v64, v64
ds_read_b128 v[124:127], v141 offset:1536
v_mfma_f32_32x32x16_bf16 v[72:87], a[60:63], v[108:111], v[72:87]
v_rcp_f32 v65, v65
v_mul_f32 v46, v46, v64
v_mul_f32 v47, v47, v65
ds_read_b128 v[104:107], v140 offset:2048
v_cvt_pk_bf16_f32 v39, v46, v47
buffer_store_dwordx4 v[36:39], v3, s[4:7], s38 offen sc1
s_waitcnt lgkmcnt(3)
v_mfma_f32_32x32x16_bf16 v[72:87], a[64:67], v[112:115], v[72:87]
s_waitcnt vmcnt(6)
s_waitcnt lgkmcnt(15)
s_barrier
v_mfma_f32_32x32x16_bf16 v[72:87], a[68:71], v[116:119], v[72:87]
v_mfma_f32_32x32x16_bf16 v[88:103], a[160:163], v[112:115], v[88:103]
ds_read_b128 v[44:47], v143
ds_read_b128 v[48:51], v143 offset:1024
s_add_u32 s24, s33, 8192
s_add_u32 m0, s27, 32768
ds_read_b128 v[108:111], v141 offset:2560
ds_read_b128 v[112:115], v140 offset:3072
s_waitcnt lgkmcnt(5)
v_mfma_f32_32x32x16_bf16 v[72:87], a[72:75], v[120:123], v[72:87]
buffer_load_dwordx4 v1, s[4:7], s24 offen offset:0 sc1 lds
buffer_load_dwordx4 v1, s[4:7], s24 offen offset:1024 sc1 lds
buffer_load_dwordx4 v1, s[4:7], s24 offen offset:2048 sc1 lds
s_waitcnt lgkmcnt(2)
v_add_f32 v52, v52, v44
v_mfma_f32_32x32x16_bf16 v[88:103], a[164:167], v[120:123], v[88:103]
v_add_f32 v53, v53, v45
v_add_f32 v54, v54, v46
v_add_f32 v55, v55, v47
buffer_load_dwordx4 v1, s[4:7], s24 offen offset:3072 sc1 lds
ds_read_b128 v[116:119], v141 offset:3584
v_mfma_f32_32x32x16_bf16 v[72:87], a[76:79], v[124:127], v[72:87]
v_add_f32 v56, v56, v48
v_add_f32 v57, v57, v49
v_add_f32 v58, v58, v50
v_add_f32 v59, v59, v51
ds_read_b128 v[120:123], v140 offset:4096
s_waitcnt lgkmcnt(3)
v_mfma_f32_32x32x16_bf16 v[72:87], a[80:83], v[104:107], v[72:87]
v_mul_f32 v64, v61, v52
buffer_load_dwordx4 v[196:199], v1, s[4:7], s56 offen offset:2048 sc1
v_mul_f32 v65, v61, v53
v_exp_f32 v64, v64
v_mfma_f32_32x32x16_bf16 v[88:103], a[168:171], v[104:107], v[88:103]
v_exp_f32 v65, v65
v_mul_f32 v52, v52, v56
v_mul_f32 v53, v53, v57
ds_read_b128 v[124:127], v141 offset:4608
v_mfma_f32_32x32x16_bf16 v[72:87], a[84:87], v[108:111], v[72:87]
buffer_load_dwordx4 v[200:203], v1, s[4:7], s40 offen offset:3072 sc1
v_fma_f32 v64, v64, v62, v62
v_fma_f32 v65, v65, v62, v62
v_rcp_f32 v64, v64
ds_read_b128 v[104:107], v140 offset:5120
s_waitcnt lgkmcnt(3)
v_mfma_f32_32x32x16_bf16 v[72:87], a[88:91], v[112:115], v[72:87]
v_rcp_f32 v65, v65
s_nop 0
s_add_u32 s40, s40, 4096
v_mfma_f32_32x32x16_bf16 v[88:103], a[172:175], v[112:115], v[88:103]
buffer_load_dwordx4 v[204:207], v1, s[4:7], s56 offen offset:3072 sc1
v_mul_f32 v52, v52, v64
v_mul_f32 v53, v53, v65
v_cvt_pk_bf16_f32 v70, v52, v53
ds_read_b128 v[108:111], v141 offset:5632
v_mfma_f32_32x32x16_bf16 v[72:87], a[92:95], v[116:119], v[72:87]
v_mul_f32 v64, v61, v54
v_mul_f32 v65, v61, v55
s_add_u32 s56, s56, 4096
buffer_load_dwordx4 v[208:211], v1, s[4:7], s40 offen offset:0 sc1
ds_read_b128 v[112:115], v140 offset:6144
s_waitcnt lgkmcnt(3)
v_mfma_f32_32x32x16_bf16 v[72:87], a[96:99], v[120:123], v[72:87]
v_exp_f32 v64, v64
v_exp_f32 v65, v65
v_mfma_f32_32x32x16_bf16 v[88:103], a[176:179], v[120:123], v[88:103]
v_mul_f32 v54, v54, v58
v_mul_f32 v55, v55, v59
v_fma_f32 v64, v64, v62, v62
buffer_load_dwordx4 v[212:215], v1, s[4:7], s56 offen offset:0 sc1
ds_read_b128 v[116:119], v141 offset:6656
v_mfma_f32_32x32x16_bf16 v[72:87], a[100:103], v[124:127], v[72:87]
v_fma_f32 v65, v65, v62, v62
v_rcp_f32 v64, v64
v_rcp_f32 v65, v65
ds_read_b128 v[120:123], v140 offset:7168
s_waitcnt lgkmcnt(3)
v_mfma_f32_32x32x16_bf16 v[72:87], a[104:107], v[104:107], v[72:87]
s_nop 0
v_mul_f32 v54, v54, v64
buffer_load_dwordx4 v[216:219], v1, s[4:7], s40 offen offset:1024 sc1
v_mul_f32 v55, v55, v65
v_mfma_f32_32x32x16_bf16 v[88:103], a[180:183], v[104:107], v[88:103]
v_cvt_pk_bf16_f32 v71, v54, v55
s_nop 0
v_permlane32_swap_b32 v68, v70
v_permlane32_swap_b32 v69, v71
ds_read_b128 v[124:127], v141 offset:7680
v_mfma_f32_32x32x16_bf16 v[72:87], a[108:111], v[108:111], v[72:87]
buffer_store_dwordx4 v[68:71], v66, s[4:7], s39 offen sc1
ds_read_b128 v[104:107], v140 offset:16384
s_waitcnt lgkmcnt(3)
v_mfma_f32_32x32x16_bf16 v[72:87], a[112:115], v[112:115], v[72:87]
v_mfma_f32_32x32x16_bf16 v[88:103], a[184:187], v[112:115], v[88:103]
ds_read_b128 v[108:111], v141 offset:16896
v_mfma_f32_32x32x16_bf16 v[72:87], a[116:119], v[116:119], v[72:87]
ds_read_b128 v[112:115], v140 offset:17408
s_waitcnt lgkmcnt(3)
v_mfma_f32_32x32x16_bf16 v[72:87], a[120:123], v[120:123], v[72:87]
v_mfma_f32_32x32x16_bf16 v[88:103], a[188:191], v[120:123], v[88:103]
ds_read_b128 v[116:119], v141 offset:17920
v_mfma_f32_32x32x16_bf16 v[72:87], a[124:127], v[124:127], v[72:87]
ds_read_b128 v[120:123], v140 offset:18432
ds_read_b128 v[60:63], v138 offset:1024
s_waitcnt lgkmcnt(4)
v_mfma_f32_32x32x16_bf16 v[36:51], a[0:3], v[104:107], 0
s_waitcnt vmcnt(7)
s_barrier
v_mfma_f32_32x32x16_bf16 v[36:51], a[4:7], v[108:111], v[36:51]
s_nop 2
ds_write_b128 v142, v[96:99]
ds_write_b128 v142, v[100:103] offset:1024
s_waitcnt lgkmcnt(2)
v_fma_f32 v52, -v60, v28, v88
v_fma_f32 v53, -v60, v29, v89
v_fma_f32 v54, -v60, v30, v90
v_fma_f32 v55, -v60, v31, v91
v_fma_f32 v56, -v60, v32, v92
v_fma_f32 v57, -v60, v33, v93
v_fma_f32 v58, -v60, v34, v94
v_fma_f32 v59, -v60, v35, v95
v_mfma_f32_32x32x16_bf16 v[88:103], a[128:131], v[104:107], 0
buffer_load_dwordx4 v[220:223], v1, s[4:7], s56 offen offset:1024 sc1
v_fma_f32 v72, -v60, v12, v72
v_fma_f32 v73, -v60, v13, v73
v_fma_f32 v76, -v60, v16, v76
ds_read_b128 v[124:127], v141 offset:18944
ds_read_b128 v[104:107], v140 offset:19456
s_waitcnt lgkmcnt(6)
v_mfma_f32_32x32x16_bf16 v[36:51], a[8:11], v[112:115], v[36:51]
v_fma_f32 v77, -v60, v17, v77
v_mul_f32 v64, v61, v72
buffer_load_dwordx4 v[224:227], v1, s[4:7], s40 offen offset:2048 sc1
v_mul_f32 v65, v61, v73
v_mfma_f32_32x32x16_bf16 v[88:103], a[132:135], v[112:115], v[88:103]
v_exp_f32 v64, v64
v_exp_f32 v65, v65
ds_read_b128 v[108:111], v141 offset:19968
v_mfma_f32_32x32x16_bf16 v[36:51], a[12:15], v[116:119], v[36:51]
v_mul_f32 v72, v72, v76
v_mul_f32 v73, v73, v77
buffer_load_dwordx4 v[228:231], v1, s[4:7], s56 offen offset:2048 sc1
v_fma_f32 v64, v64, v62, v62
ds_read_b128 v[112:115], v140 offset:20480
s_waitcnt lgkmcnt(3)
v_mfma_f32_32x32x16_bf16 v[36:51], a[16:19], v[120:123], v[36:51]
v_fma_f32 v65, v65, v62, v62
v_rcp_f32 v64, v64
v_rcp_f32 v65, v65
v_mfma_f32_32x32x16_bf16 v[88:103], a[136:139], v[120:123], v[88:103]
v_fma_f32 v74, -v60, v14, v74
buffer_load_dwordx4 v[232:235], v1, s[4:7], s40 offen offset:3072 sc1
v_fma_f32 v75, -v60, v15, v75
v_fma_f32 v78, -v60, v18, v78
ds_read_b128 v[116:119], v141 offset:20992
v_mfma_f32_32x32x16_bf16 v[36:51], a[20:23], v[124:127], v[36:51]
v_fma_f32 v79, -v60, v19, v79
v_mul_f32 v72, v72, v64
v_mul_f32 v73, v73, v65
s_add_u32 s40, s40, 4096
ds_read_b128 v[120:123], v140 offset:21504
s_waitcnt vmcnt(4)
s_cmp_eq_u32 s16, 3
s_barrier
s_cbranch_scc1 SIG_88_s
SIG_88:
buffer_load_dword v67, v3, s[4:7], s37 offen offset:0 sc1
buffer_load_dword v67, v3, s[4:7], s38 offen offset:0 sc1
buffer_load_dword v67, v66, s[4:7], s39 offen offset:0 sc1
s_waitcnt lgkmcnt(3)
v_mfma_f32_32x32x16_bf16 v[36:51], a[24:27], v[104:107], v[36:51]
s_cmp_eq_u32 s16, 3
s_cselect_b32 s40, 0x40000000, s40
buffer_load_dwordx4 v[236:239], v1, s[4:7], s56 offen offset:3072 sc1
v_cvt_pk_bf16_f32 v72, v72, v73
v_mfma_f32_32x32x16_bf16 v[88:103], a[140:143], v[104:107], v[88:103]
v_mul_f32 v64, v61, v74
v_mul_f32 v65, v61, v75
v_exp_f32 v64, v64
ds_read_b128 v[124:127], v141 offset:22016
v_mfma_f32_32x32x16_bf16 v[36:51], a[28:31], v[108:111], v[36:51]
v_exp_f32 v65, v65
s_add_u32 s56, s56, 4096
s_cmp_eq_u32 s16, 3
ds_read_b128 v[104:107], v140 offset:22528
s_waitcnt lgkmcnt(3)
v_mfma_f32_32x32x16_bf16 v[36:51], a[32:35], v[112:115], v[36:51]
s_cselect_b32 s56, 0x40000000, s56
buffer_load_dwordx4 v[240:243], v1, s[4:7], s40 offen offset:0 sc1
v_mul_f32 v74, v74, v78
v_mul_f32 v75, v75, v79
v_mfma_f32_32x32x16_bf16 v[88:103], a[144:147], v[112:115], v[88:103]
v_fma_f32 v64, v64, v62, v62
v_fma_f32 v65, v65, v62, v62
v_rcp_f32 v64, v64
ds_read_b128 v[108:111], v141 offset:23040
v_mfma_f32_32x32x16_bf16 v[36:51], a[36:39], v[116:119], v[36:51]
buffer_load_dwordx4 v[244:247], v1, s[4:7], s56 offen offset:0 sc1
v_rcp_f32 v65, v65
v_fma_f32 v80, -v60, v20, v80
ds_read_b128 v[112:115], v140 offset:23552
s_waitcnt lgkmcnt(3)
v_mfma_f32_32x32x16_bf16 v[36:51], a[40:43], v[120:123], v[36:51]
v_fma_f32 v81, -v60, v21, v81
v_fma_f32 v84, -v60, v24, v84
v_fma_f32 v85, -v60, v25, v85
v_mul_f32 v74, v74, v64
v_mfma_f32_32x32x16_bf16 v[88:103], a[148:151], v[120:123], v[88:103]
v_mul_f32 v75, v75, v65
v_cvt_pk_bf16_f32 v73, v74, v75
v_mul_f32 v64, v61, v80
v_mul_f32 v65, v61, v81
ds_read_b128 v[116:119], v141 offset:24064
v_mfma_f32_32x32x16_bf16 v[36:51], a[44:47], v[124:127], v[36:51]
v_exp_f32 v64, v64
v_exp_f32 v65, v65
ds_read_b128 v[120:123], v140 offset:32768
s_waitcnt lgkmcnt(3)
v_mfma_f32_32x32x16_bf16 v[36:51], a[48:51], v[104:107], v[36:51]
v_mul_f32 v80, v80, v84
v_mul_f32 v81, v81, v85
v_fma_f32 v64, v64, v62, v62
v_fma_f32 v65, v65, v62, v62
v_mfma_f32_32x32x16_bf16 v[88:103], a[152:155], v[104:107], v[88:103]
v_rcp_f32 v64, v64
v_rcp_f32 v65, v65
ds_read_b128 v[124:127], v141 offset:33280
v_mfma_f32_32x32x16_bf16 v[36:51], a[52:55], v[108:111], v[36:51]
v_fma_f32 v82, -v60, v22, v82
v_fma_f32 v83, -v60, v23, v83
v_fma_f32 v86, -v60, v26, v86
v_fma_f32 v87, -v60, v27, v87
ds_read_b128 v[104:107], v140 offset:33792
s_waitcnt lgkmcnt(3)
v_mfma_f32_32x32x16_bf16 v[36:51], a[56:59], v[112:115], v[36:51]
v_mul_f32 v80, v80, v64
v_mul_f32 v81, v81, v65
v_cvt_pk_bf16_f32 v74, v80, v81
v_mul_f32 v64, v61, v82
v_mfma_f32_32x32x16_bf16 v[88:103], a[156:159], v[112:115], v[88:103]
v_mul_f32 v65, v61, v83
v_exp_f32 v64, v64
v_exp_f32 v65, v65
ds_read_b128 v[108:111], v141 offset:34304
v_mfma_f32_32x32x16_bf16 v[36:51], a[60:63], v[116:119], v[36:51]
v_mul_f32 v82, v82, v86
v_mul_f32 v83, v83, v87
v_fma_f32 v64, v64, v62, v62
v_fma_f32 v65, v65, v62, v62
ds_read_b128 v[112:115], v140 offset:34816
v_rcp_f32 v64, v64
v_rcp_f32 v65, v65
v_mul_f32 v82, v82, v64
v_mul_f32 v83, v83, v65
v_cvt_pk_bf16_f32 v75, v82, v83
s_add_u32 s37, s37, 176128
s_add_u32 s38, s38, 176128
buffer_store_dwordx4 v[72:75], v3, s[4:7], s37 offen sc1
s_lshr_b32 s29, s15, 3
s_lshl_b32 s29, s29, 1
s_lshl_b32 s24, s14, 3
s_add_u32 s29, s29, s24
s_and_b32 s30, s15, 7
s_mul_i32 s31, s29, 44032
s_mul_i32 s24, s16, 11264
s_add_u32 s31, s31, s24
s_add_u32 s31, s31, s17
s_add_u32 s31, s31, 9437184
s_add_u32 s32, s31, 4096
s_add_u32 s33, s31, 8192
s_cmp_eq_u32 s16, 3
s_cselect_b32 s34, 0x40000000, s33
s_lshl_b32 s57, s16, 13
s_add_u32 s57, s57, 98304
s_add_u32 s58, s27, 32768
s_waitcnt lgkmcnt(3)
v_mfma_f32_32x32x16_bf16 v[36:51], a[64:67], v[120:123], v[36:51]
s_waitcnt lgkmcnt(15)
s_barrier
v_mfma_f32_32x32x16_bf16 v[36:51], a[68:71], v[124:127], v[36:51]
v_mfma_f32_32x32x16_bf16 v[88:103], a[160:163], v[120:123], v[88:103]
ds_read_b128 v[80:83], v143
ds_read_b128 v[84:87], v143 offset:1024
buffer_load_dwordx4 v[248:251], v1, s[4:7], s40 offen offset:1024 sc1
buffer_load_dwordx4 v[252:255], v1, s[4:7], s56 offen offset:1024 sc1
ds_read_b128 v[116:119], v141 offset:35328
ds_read_b128 v[120:123], v140 offset:35840
s_waitcnt lgkmcnt(5)
v_mfma_f32_32x32x16_bf16 v[36:51], a[72:75], v[104:107], v[36:51]
s_mov_b64 exec, 0xffff
buffer_load_dword v67, v1, s[4:7], s3 offen sc1
s_mov_b64 exec, -1
s_waitcnt lgkmcnt(2)
v_add_f32 v52, v52, v80
v_add_f32 v53, v53, v81
v_add_f32 v54, v54, v82
v_mfma_f32_32x32x16_bf16 v[88:103], a[164:167], v[104:107], v[88:103]
v_add_f32 v55, v55, v83
v_add_f32 v56, v56, v84
v_add_f32 v57, v57, v85
v_add_f32 v58, v58, v86
ds_read_b128 v[124:127], v141 offset:36352
v_mfma_f32_32x32x16_bf16 v[36:51], a[76:79], v[108:111], v[36:51]
v_add_f32 v59, v59, v87
v_mul_f32 v64, v61, v52
v_mul_f32 v65, v61, v53
v_exp_f32 v64, v64
ds_read_b128 v[104:107], v140 offset:36864
s_waitcnt lgkmcnt(3)
v_mfma_f32_32x32x16_bf16 v[36:51], a[80:83], v[112:115], v[36:51]
v_exp_f32 v65, v65
v_mul_f32 v52, v52, v56
v_mul_f32 v53, v53, v57
v_mfma_f32_32x32x16_bf16 v[88:103], a[168:171], v[112:115], v[88:103]
v_fma_f32 v64, v64, v62, v62
v_fma_f32 v65, v65, v62, v62
v_rcp_f32 v64, v64
ds_read_b128 v[108:111], v141 offset:37376
v_mfma_f32_32x32x16_bf16 v[36:51], a[84:87], v[116:119], v[36:51]
v_rcp_f32 v65, v65
s_nop 0
v_mul_f32 v52, v52, v64
ds_read_b128 v[112:115], v140 offset:37888
s_waitcnt lgkmcnt(3)
v_mfma_f32_32x32x16_bf16 v[36:51], a[88:91], v[120:123], v[36:51]
v_mul_f32 v53, v53, v65
v_cvt_pk_bf16_f32 v68, v52, v53
v_mul_f32 v64, v61, v54
v_mul_f32 v65, v61, v55
v_mfma_f32_32x32x16_bf16 v[88:103], a[172:175], v[120:123], v[88:103]
v_exp_f32 v64, v64
v_exp_f32 v65, v65
ds_read_b128 v[116:119], v141 offset:38400
v_mfma_f32_32x32x16_bf16 v[36:51], a[92:95], v[124:127], v[36:51]
v_mul_f32 v54, v54, v58
v_mul_f32 v55, v55, v59
v_fma_f32 v64, v64, v62, v62
ds_read_b128 v[120:123], v140 offset:38912
s_add_u32 s23, s55, 4
s_waitcnt vmcnt(0)
v_cmp_gt_u32 s[96:97], s23, v67
s_nop 0
s_and_b32 s96, s96, 0xffff
s_cbranch_scc1 AP_89_s
AP_89:
s_waitcnt lgkmcnt(3)
v_mfma_f32_32x32x16_bf16 v[36:51], a[96:99], v[104:107], v[36:51]
s_add_u32 m0, s57, 0
s_nop 0
buffer_load_dwordx4 v3, s[4:7], s31 offen offset:0 sc1 lds
v_fma_f32 v65, v65, v62, v62
v_rcp_f32 v64, v64
v_mfma_f32_32x32x16_bf16 v[88:103], a[176:179], v[104:107], v[88:103]
v_rcp_f32 v65, v65
s_nop 0
s_add_u32 m0, s57, 512
ds_read_b128 v[124:127], v141 offset:39424
v_mfma_f32_32x32x16_bf16 v[36:51], a[100:103], v[108:111], v[36:51]
buffer_load_dwordx4 v3, s[4:7], s31 offen offset:512 sc1 lds
v_mul_f32 v54, v54, v64
v_mul_f32 v55, v55, v65
v_cvt_pk_bf16_f32 v69, v54, v55
ds_read_b128 v[104:107], v140 offset:39936
s_waitcnt lgkmcnt(3)
v_mfma_f32_32x32x16_bf16 v[36:51], a[104:107], v[112:115], v[36:51]
s_nop 0
s_add_u32 m0, s57, 1024
s_nop 0
buffer_load_dwordx4 v3, s[4:7], s31 offen offset:1024 sc1 lds
s_nop 0
v_mfma_f32_32x32x16_bf16 v[88:103], a[180:183], v[112:115], v[88:103]
s_nop 0
s_nop 0
s_nop 0
s_add_u32 m0, s57, 1536
ds_read_b128 v[108:111], v141 offset:40448
v_mfma_f32_32x32x16_bf16 v[36:51], a[108:111], v[116:119], v[36:51]
buffer_load_dwordx4 v3, s[4:7], s31 offen offset:1536 sc1 lds
s_nop 0
s_nop 0
s_nop 0
s_waitcnt lgkmcnt(2)
v_mfma_f32_32x32x16_bf16 v[36:51], a[112:115], v[120:123], v[36:51]
s_nop 0
s_add_u32 m0, s57, 2048
s_nop 0
buffer_load_dwordx4 v3, s[4:7], s31 offen offset:2048 sc1 lds
s_nop 0
v_mfma_f32_32x32x16_bf16 v[88:103], a[184:187], v[120:123], v[88:103]
s_nop 0
s_nop 0
s_nop 0
s_add_u32 m0, s57, 2560
v_mfma_f32_32x32x16_bf16 v[36:51], a[116:119], v[124:127], v[36:51]
buffer_load_dwordx4 v3, s[4:7], s31 offen offset:2560 sc1 lds
s_nop 0
s_nop 0
s_nop 0
s_waitcnt lgkmcnt(0)
v_mfma_f32_32x32x16_bf16 v[36:51], a[120:123], v[104:107], v[36:51]
s_nop 0
s_add_u32 m0, s57, 3072
s_nop 0
buffer_load_dwordx4 v3, s[4:7], s31 offen offset:3072 sc1 lds
s_nop 0
v_mfma_f32_32x32x16_bf16 v[88:103], a[188:191], v[104:107], v[88:103]
s_nop 0
s_nop 0
s_nop 0
s_add_u32 m0, s57, 3584
v_mfma_f32_32x32x16_bf16 v[36:51], a[124:127], v[108:111], v[36:51]
buffer_load_dwordx4 v3, s[4:7], s31 offen offset:3584 sc1 lds
s_nop 0
s_nop 0
s_nop 0
ds_read_b128 v[60:63], v139 offset:1024
s_nop 1
ds_write_b128 v142, v[96:99]
ds_write_b128 v142, v[100:103] offset:1024
s_waitcnt lgkmcnt(2)
v_fma_f32 v52, -v60, v28, v88
v_fma_f32 v53, -v60, v29, v89
v_fma_f32 v54, -v60, v30, v90
v_fma_f32 v55, -v60, v31, v91
v_fma_f32 v56, -v60, v32, v92
v_fma_f32 v57, -v60, v33, v93
v_fma_f32 v58, -v60, v34, v94
v_fma_f32 v59, -v60, v35, v95
s_waitcnt lgkmcnt(0)
s_barrier
s_waitcnt vmcnt(0)
ds_read_b128 v[72:75], v9 offset:0
ds_read_b128 v[76:79], v9 offset:1024
buffer_load_dwordx4 v[84:87], v3, s[4:7], s32 offen offset:0 sc1
ds_read_b128 v[28:31], v143
ds_read_b128 v[32:35], v143 offset:1024
v_fma_f32 v36, -v60, v12, v36
v_fma_f32 v37, -v60, v13, v37
buffer_load_dwordx4 v[88:91], v3, s[4:7], s32 offen offset:512 sc1
v_fma_f32 v40, -v60, v16, v40
v_fma_f32 v41, -v60, v17, v41
s_waitcnt lgkmcnt(3)
v_mfma_f32_32x32x16_bf16 v[112:127], a[192:195], v[72:75], 0
v_mul_f32 v64, v61, v36
v_mul_f32 v65, v61, v37
v_exp_f32 v64, v64
ds_read_b128 v[80:83], v9 offset:2048
buffer_load_dwordx4 v[92:95], v3, s[4:7], s32 offen offset:1024 sc1
v_mfma_f32_32x32x16_bf16 v[128:143], a[196:199], v[72:75], 0
v_exp_f32 v65, v65
v_mul_f32 v36, v36, v40
v_mul_f32 v37, v37, v41
s_waitcnt lgkmcnt(3)
v_mfma_f32_32x32x16_bf16 v[112:127], a[200:203], v[76:79], v[112:127]
v_fma_f32 v64, v64, v62, v62
v_fma_f32 v65, v65, v62, v62
v_rcp_f32 v64, v64
ds_read_b128 v[72:75], v9 offset:3072
buffer_load_dwordx4 v[96:99], v3, s[4:7], s32 offen offset:1536 sc1
v_mfma_f32_32x32x16_bf16 v[128:143], a[204:207], v[76:79], v[128:143]
v_rcp_f32 v65, v65
v_fma_f32 v38, -v60, v14, v38
v_fma_f32 v39, -v60, v15, v39
s_waitcnt lgkmcnt(1)
v_mfma_f32_32x32x16_bf16 v[112:127], a[208:211], v[80:83], v[112:127]
v_fma_f32 v42, -v60, v18, v42
v_fma_f32 v43, -v60, v19, v43
v_mul_f32 v36, v36, v64
v_mul_f32 v37, v37, v65
ds_read_b128 v[76:79], v9 offset:4096
buffer_load_dwordx4 v[100:103], v3, s[4:7], s32 offen offset:2048 sc1
v_mfma_f32_32x32x16_bf16 v[128:143], a[212:215], v[80:83], v[128:143]
v_cvt_pk_bf16_f32 v36, v36, v37
v_mul_f32 v64, v61, v38
v_mul_f32 v65, v61, v39
v_exp_f32 v64, v64
s_waitcnt lgkmcnt(1)
v_mfma_f32_32x32x16_bf16 v[112:127], a[216:219], v[72:75], v[112:127]
v_exp_f32 v65, v65
v_mul_f32 v38, v38, v42
v_mul_f32 v39, v39, v43
ds_read_b128 v[80:83], v9 offset:5120
buffer_load_dwordx4 v[104:107], v3, s[4:7], s32 offen offset:2560 sc1
v_mfma_f32_32x32x16_bf16 v[128:143], a[220:223], v[72:75], v[128:143]
v_fma_f32 v64, v64, v62, v62
v_fma_f32 v65, v65, v62, v62
v_rcp_f32 v64, v64
s_waitcnt lgkmcnt(1)
v_mfma_f32_32x32x16_bf16 v[112:127], a[224:227], v[76:79], v[112:127]
v_rcp_f32 v65, v65
v_fma_f32 v44, -v60, v20, v44
v_fma_f32 v45, -v60, v21, v45
ds_read_b128 v[72:75], v9 offset:6144
buffer_load_dwordx4 v[108:111], v3, s[4:7], s32 offen offset:3072 sc1
v_mfma_f32_32x32x16_bf16 v[128:143], a[228:231], v[76:79], v[128:143]
v_fma_f32 v48, -v60, v24, v48
v_fma_f32 v49, -v60, v25, v49
v_mul_f32 v38, v38, v64
v_mul_f32 v39, v39, v65
s_waitcnt lgkmcnt(1)
v_mfma_f32_32x32x16_bf16 v[112:127], a[232:235], v[80:83], v[112:127]
v_cvt_pk_bf16_f32 v37, v38, v39
v_mul_f32 v64, v61, v44
v_mul_f32 v65, v61, v45
v_exp_f32 v64, v64
ds_read_b128 v[76:79], v9 offset:7168
v_mfma_f32_32x32x16_bf16 v[128:143], a[236:239], v[80:83], v[128:143]
v_exp_f32 v65, v65
v_mul_f32 v44, v44, v48
v_mul_f32 v45, v45, v49
s_waitcnt lgkmcnt(1)
v_mfma_f32_32x32x16_bf16 v[112:127], a[240:243], v[72:75], v[112:127]
v_fma_f32 v64, v64, v62, v62
v_fma_f32 v65, v65, v62, v62
v_rcp_f32 v64, v64
v_mfma_f32_32x32x16_bf16 v[128:143], a[244:247], v[72:75], v[128:143]
v_rcp_f32 v65, v65
v_fma_f32 v46, -v60, v22, v46
v_fma_f32 v47, -v60, v23, v47
s_waitcnt lgkmcnt(0)
v_mfma_f32_32x32x16_bf16 v[112:127], a[248:251], v[76:79], v[112:127]
v_fma_f32 v50, -v60, v26, v50
v_fma_f32 v51, -v60, v27, v51
v_mul_f32 v44, v44, v64
v_mul_f32 v45, v45, v65
v_mfma_f32_32x32x16_bf16 v[128:143], a[252:255], v[76:79], v[128:143]
v_cvt_pk_bf16_f32 v38, v44, v45
v_mul_f32 v64, v61, v46
v_mul_f32 v65, v61, v47
v_exp_f32 v64, v64
buffer_load_dwordx4 v[72:75], v3, s[4:7], s32 offen offset:3584 sc1
s_waitcnt vmcnt(7)
v_mfma_f32_32x32x16_bf16 v[112:127], v[144:147], v[84:87], v[112:127]
v_exp_f32 v65, v65
v_mul_f32 v46, v46, v50
v_mul_f32 v47, v47, v51
buffer_load_dwordx4 v[76:79], v3, s[4:7], s33 offen offset:0 sc1
v_mfma_f32_32x32x16_bf16 v[128:143], v[148:151], v[84:87], v[128:143]
v_fma_f32 v64, v64, v62, v62
v_fma_f32 v65, v65, v62, v62
v_rcp_f32 v64, v64
buffer_load_dwordx4 v[80:83], v3, s[4:7], s33 offen offset:512 sc1
s_waitcnt vmcnt(8)
v_mfma_f32_32x32x16_bf16 v[112:127], v[152:155], v[88:91], v[112:127]
v_rcp_f32 v65, v65
v_mul_f32 v46, v46, v64
v_mul_f32 v47, v47, v65
buffer_load_dwordx4 v[84:87], v3, s[4:7], s33 offen offset:1024 sc1
v_mfma_f32_32x32x16_bf16 v[128:143], v[156:159], v[88:91], v[128:143]
v_cvt_pk_bf16_f32 v39, v46, v47
buffer_store_dwordx4 v[36:39], v3, s[4:7], s38 offen sc1
s_waitcnt lgkmcnt(6)
v_add_f32 v52, v52, v28
v_add_f32 v53, v53, v29
buffer_load_dwordx4 v[88:91], v3, s[4:7], s33 offen offset:1536 sc1
s_waitcnt vmcnt(10)
v_mfma_f32_32x32x16_bf16 v[112:127], v[160:163], v[92:95], v[112:127]
v_add_f32 v54, v54, v30
v_add_f32 v55, v55, v31
v_add_f32 v56, v56, v32
v_add_f32 v57, v57, v33
v_mfma_f32_32x32x16_bf16 v[128:143], v[164:167], v[92:95], v[128:143]
v_add_f32 v58, v58, v34
v_add_f32 v59, v59, v35
v_mul_f32 v64, v61, v52
v_mul_f32 v65, v61, v53
buffer_load_dwordx4 v[92:95], v3, s[4:7], s34 offen offset:2048 sc1
s_waitcnt vmcnt(10)
v_mfma_f32_32x32x16_bf16 v[112:127], v[168:171], v[96:99], v[112:127]
v_exp_f32 v64, v64
v_exp_f32 v65, v65
v_mfma_f32_32x32x16_bf16 v[128:143], v[172:175], v[96:99], v[128:143]
v_mul_f32 v52, v52, v56
v_mul_f32 v53, v53, v57
v_fma_f32 v64, v64, v62, v62
v_fma_f32 v65, v65, v62, v62
buffer_load_dwordx4 v[96:99], v3, s[4:7], s34 offen offset:2560 sc1
s_waitcnt vmcnt(10)
v_mfma_f32_32x32x16_bf16 v[112:127], v[176:179], v[100:103], v[112:127]
v_rcp_f32 v64, v64
v_rcp_f32 v65, v65
v_mfma_f32_32x32x16_bf16 v[128:143], v[180:183], v[100:103], v[128:143]
s_nop 0
v_mul_f32 v52, v52, v64
v_mul_f32 v53, v53, v65
v_cvt_pk_bf16_f32 v70, v52, v53
s_waitcnt vmcnt(9)
v_mfma_f32_32x32x16_bf16 v[112:127], v[184:187], v[104:107], v[112:127]
v_mul_f32 v64, v61, v54
v_mul_f32 v65, v61, v55
v_exp_f32 v64, v64
v_mfma_f32_32x32x16_bf16 v[128:143], v[188:191], v[104:107], v[128:143]
v_exp_f32 v65, v65
v_mul_f32 v54, v54, v58
v_mul_f32 v55, v55, v59
s_waitcnt vmcnt(8)
v_mfma_f32_32x32x16_bf16 v[112:127], v[192:195], v[108:111], v[112:127]
v_fma_f32 v64, v64, v62, v62
v_fma_f32 v65, v65, v62, v62
v_rcp_f32 v64, v64
v_mfma_f32_32x32x16_bf16 v[128:143], v[196:199], v[108:111], v[128:143]
v_rcp_f32 v65, v65
s_nop 0
v_mul_f32 v54, v54, v64
s_waitcnt vmcnt(7)
v_mfma_f32_32x32x16_bf16 v[112:127], v[200:203], v[72:75], v[112:127]
v_mul_f32 v55, v55, v65
v_cvt_pk_bf16_f32 v71, v54, v55
s_nop 0
v_permlane32_swap_b32 v68, v70
v_mfma_f32_32x32x16_bf16 v[128:143], v[204:207], v[72:75], v[128:143]
v_permlane32_swap_b32 v69, v71
s_add_u32 s39, s39, 176128
buffer_store_dwordx4 v[68:71], v66, s[4:7], s39 offen sc1
buffer_load_dwordx4 v[56:59], v4, s[4:7], s52 offen sc1
s_waitcnt vmcnt(8)
v_mfma_f32_32x32x16_bf16 v[112:127], v[208:211], v[76:79], v[112:127]
v_mfma_f32_32x32x16_bf16 v[128:143], v[212:215], v[76:79], v[128:143]
s_waitcnt vmcnt(7)
v_mfma_f32_32x32x16_bf16 v[112:127], v[216:219], v[80:83], v[112:127]
v_mfma_f32_32x32x16_bf16 v[128:143], v[220:223], v[80:83], v[128:143]
s_waitcnt vmcnt(6)
v_mfma_f32_32x32x16_bf16 v[112:127], v[224:227], v[84:87], v[112:127]
v_mfma_f32_32x32x16_bf16 v[128:143], v[228:231], v[84:87], v[128:143]
s_waitcnt vmcnt(4)
v_mfma_f32_32x32x16_bf16 v[112:127], v[232:235], v[88:91], v[112:127]
v_mfma_f32_32x32x16_bf16 v[128:143], v[236:239], v[88:91], v[128:143]
s_waitcnt vmcnt(1)
s_cmp_eq_u32 s16, 3
s_barrier
s_cbranch_scc1 SIG_90_s
SIG_90:
buffer_load_dword v67, v3, s[4:7], s37 offen offset:0 sc1
buffer_load_dword v67, v3, s[4:7], s38 offen offset:0 sc1
buffer_load_dword v67, v66, s[4:7], s39 offen offset:0 sc1
s_waitcnt vmcnt(6)
v_mfma_f32_32x32x16_bf16 v[112:127], v[240:243], v[92:95], v[112:127]
v_mfma_f32_32x32x16_bf16 v[128:143], v[244:247], v[92:95], v[128:143]
s_waitcnt vmcnt(5)
v_mfma_f32_32x32x16_bf16 v[112:127], v[248:251], v[96:99], v[112:127]
v_mfma_f32_32x32x16_bf16 v[128:143], v[252:255], v[96:99], v[128:143]
s_nop 10
ds_write_b128 v8, v[112:115] offset:0
ds_write_b128 v8, v[116:119] offset:1024
ds_write_b128 v8, v[120:123] offset:8192
ds_write_b128 v8, v[124:127] offset:9216
ds_write_b128 v8, v[128:131] offset:16384
ds_write_b128 v8, v[132:135] offset:17408
ds_write_b128 v8, v[136:139] offset:24576
ds_write_b128 v8, v[140:143] offset:25600
s_mov_b64 exec, 0xffff
buffer_load_dword v67, v1, s[4:7], s3 offen sc1
s_mov_b64 exec, -1
s_waitcnt lgkmcnt(0)
s_barrier
ds_read_b128 v[112:115], v6 offset:0
ds_read_b128 v[116:119], v6 offset:1024
ds_read_b128 v[120:123], v6 offset:2048
ds_read_b128 v[124:127], v6 offset:3072
ds_read_b128 v[128:131], v6 offset:4096
ds_read_b128 v[132:135], v6 offset:5120
ds_read_b128 v[136:139], v6 offset:6144
ds_read_b128 v[140:143], v6 offset:7168
s_add_u32 s31, s31, 176128
s_add_u32 s32, s32, 176128
s_add_u32 s33, s33, 176128
s_add_u32 s34, s34, 176128
s_add_u32 s23, s55, 5
s_waitcnt vmcnt(0)
v_cmp_gt_u32 s[96:97], s23, v67
s_nop 0
s_and_b32 s96, s96, 0xffff
s_cbranch_scc1 AP_91_s
AP_91:
s_add_u32 m0, s58, 0
s_nop 0
buffer_load_dwordx4 v3, s[4:7], s31 offen offset:0 sc1 lds
s_waitcnt vmcnt(5)
s_waitcnt lgkmcnt(4)
v_pk_add_f32 v[112:113], v[112:113], v[120:121]
s_add_u32 m0, s58, 512
s_nop 0
buffer_load_dwordx4 v3, s[4:7], s31 offen offset:512 sc1 lds
v_pk_add_f32 v[114:115], v[114:115], v[122:123]
v_pk_add_f32 v[116:117], v[116:117], v[124:125]
v_pk_add_f32 v[118:119], v[118:119], v[126:127]
s_add_u32 m0, s58, 1024
s_nop 0
buffer_load_dwordx4 v3, s[4:7], s31 offen offset:1024 sc1 lds
v_lshlrev_b32 v120, 16, v56
v_and_b32 v121, 0xffff0000, v56
v_lshlrev_b32 v122, 16, v57
s_add_u32 m0, s58, 1536
s_nop 0
buffer_load_dwordx4 v3, s[4:7], s31 offen offset:1536 sc1 lds
v_and_b32 v123, 0xffff0000, v57
v_lshlrev_b32 v124, 16, v58
v_and_b32 v125, 0xffff0000, v58
buffer_load_dwordx4 v[84:87], v3, s[4:7], s31 offen offset:2048 sc1
v_lshlrev_b32 v126, 16, v59
v_and_b32 v127, 0xffff0000, v59
s_waitcnt lgkmcnt(0)
buffer_load_dwordx4 v[88:91], v3, s[4:7], s31 offen offset:2560 sc1
v_pk_add_f32 v[128:129], v[128:129], v[136:137]
v_pk_add_f32 v[112:113], v[112:113], v[120:121]
v_pk_add_f32 v[130:131], v[130:131], v[138:139]
buffer_load_dwordx4 v[92:95], v3, s[4:7], s31 offen offset:3072 sc1
v_pk_add_f32 v[114:115], v[114:115], v[122:123]
v_pk_add_f32 v[132:133], v[132:133], v[140:141]
v_pk_add_f32 v[116:117], v[116:117], v[124:125]
buffer_load_dwordx4 v[96:99], v3, s[4:7], s31 offen offset:3584 sc1
v_pk_add_f32 v[134:135], v[134:135], v[142:143]
v_pk_add_f32 v[118:119], v[118:119], v[126:127]
v_pk_add_f32 v[112:113], v[112:113], v[128:129]
buffer_load_dwordx4 v[100:103], v3, s[4:7], s32 offen offset:0 sc1
v_pk_add_f32 v[114:115], v[114:115], v[130:131]
v_pk_add_f32 v[116:117], v[116:117], v[132:133]
v_pk_add_f32 v[118:119], v[118:119], v[134:135]
buffer_load_dwordx4 v[104:107], v3, s[4:7], s32 offen offset:512 sc1
v_cvt_pk_bf16_f32 v120, v112, v113
v_cvt_pk_bf16_f32 v121, v114, v115
v_cvt_pk_bf16_f32 v122, v116, v117
buffer_load_dwordx4 v[108:111], v3, s[4:7], s32 offen offset:1024 sc1
v_cvt_pk_bf16_f32 v123, v118, v119
buffer_store_dwordx4 v[120:123], v5, s[64:67], s53 offen sc1
s_waitcnt vmcnt(8)
ds_read_b128 v[72:75], v10 offset:0
ds_read_b128 v[76:79], v10 offset:1024
s_waitcnt lgkmcnt(1)
v_mfma_f32_32x32x16_bf16 v[24:39], a[192:195], v[72:75], 0
v_add_f32 v60, v112, v113
v_mul_f32 v61, v112, v112
v_fmac_f32 v61, v113, v113
v_add_f32 v60, v60, v114
v_fmac_f32 v61, v114, v114
ds_read_b128 v[80:83], v10 offset:2048
v_mfma_f32_32x32x16_bf16 v[40:55], a[196:199], v[72:75], 0
v_add_f32 v60, v60, v115
v_fmac_f32 v61, v115, v115
v_add_f32 v60, v60, v116
v_fmac_f32 v61, v116, v116
v_add_f32 v60, v60, v117
s_waitcnt lgkmcnt(1)
v_mfma_f32_32x32x16_bf16 v[24:39], a[200:203], v[76:79], v[24:39]
v_fmac_f32 v61, v117, v117
v_add_f32 v60, v60, v118
v_fmac_f32 v61, v118, v118
v_add_f32 v60, v60, v119
v_fmac_f32 v61, v119, v119
ds_read_b128 v[72:75], v10 offset:3072
v_mfma_f32_32x32x16_bf16 v[40:55], a[204:207], v[76:79], v[40:55]
v_permlane32_swap_b32 v60, v61
v_add_f32 v60, v60, v61
v_mov_b32 v61, v60
s_nop 1
v_permlane16_swap_b32 v60, v61
v_add_f32 v60, v60, v61
s_waitcnt lgkmcnt(1)
v_mfma_f32_32x32x16_bf16 v[24:39], a[208:211], v[80:83], v[24:39]
v_add_f32_dpp v60, v60, v60 row_ror:8 row_mask:0xf bank_mask:0xf
buffer_store_dword v60, v7, s[4:7], s54 offen sc1
s_add_u32 s52, s52, 65536
buffer_load_dwordx4 v[56:59], v4, s[4:7], s52 offen sc1
v_mfma_f32_32x32x16_bf16 v[40:55], a[212:215], v[80:83], v[40:55]
s_waitcnt lgkmcnt(0)
v_mfma_f32_32x32x16_bf16 v[24:39], a[216:219], v[72:75], v[24:39]
v_mfma_f32_32x32x16_bf16 v[40:55], a[220:223], v[72:75], v[40:55]
buffer_load_dwordx4 v[72:75], v3, s[4:7], s32 offen offset:1536 sc1
s_waitcnt vmcnt(10)
v_mfma_f32_32x32x16_bf16 v[24:39], a[224:227], v[84:87], v[24:39]
buffer_load_dwordx4 v[76:79], v3, s[4:7], s32 offen offset:2048 sc1
v_mfma_f32_32x32x16_bf16 v[40:55], a[228:231], v[84:87], v[40:55]
buffer_load_dwordx4 v[80:83], v3, s[4:7], s32 offen offset:2560 sc1
s_waitcnt vmcnt(11)
v_mfma_f32_32x32x16_bf16 v[24:39], a[232:235], v[88:91], v[24:39]
v_mfma_f32_32x32x16_bf16 v[40:55], a[236:239], v[88:91], v[40:55]
s_waitcnt vmcnt(10)
v_mfma_f32_32x32x16_bf16 v[24:39], a[240:243], v[92:95], v[24:39]
buffer_load_dwordx4 v[112:115], v3, s[4:7], s32 offen offset:3072 sc1
v_mfma_f32_32x32x16_bf16 v[40:55], a[244:247], v[92:95], v[40:55]
s_waitcnt vmcnt(10)
v_mfma_f32_32x32x16_bf16 v[24:39], a[248:251], v[96:99], v[24:39]
buffer_load_dwordx4 v[116:119], v3, s[4:7], s32 offen offset:3584 sc1
v_mfma_f32_32x32x16_bf16 v[40:55], a[252:255], v[96:99], v[40:55]
s_waitcnt vmcnt(10)
v_mfma_f32_32x32x16_bf16 v[24:39], v[144:147], v[100:103], v[24:39]
buffer_load_dwordx4 v[120:123], v3, s[4:7], s33 offen offset:0 sc1
v_mfma_f32_32x32x16_bf16 v[40:55], v[148:151], v[100:103], v[40:55]
s_waitcnt vmcnt(10)
v_mfma_f32_32x32x16_bf16 v[24:39], v[152:155], v[104:107], v[24:39]
buffer_load_dwordx4 v[124:127], v3, s[4:7], s33 offen offset:512 sc1
v_mfma_f32_32x32x16_bf16 v[40:55], v[156:159], v[104:107], v[40:55]
s_waitcnt vmcnt(10)
v_mfma_f32_32x32x16_bf16 v[24:39], v[160:163], v[108:111], v[24:39]
buffer_load_dwordx4 v[128:131], v3, s[4:7], s33 offen offset:1024 sc1
v_mfma_f32_32x32x16_bf16 v[40:55], v[164:167], v[108:111], v[40:55]
s_waitcnt vmcnt(7)
v_mfma_f32_32x32x16_bf16 v[24:39], v[168:171], v[72:75], v[24:39]
buffer_load_dwordx4 v[132:135], v3, s[4:7], s33 offen offset:1536 sc1
v_mfma_f32_32x32x16_bf16 v[40:55], v[172:175], v[72:75], v[40:55]
s_waitcnt vmcnt(7)
v_mfma_f32_32x32x16_bf16 v[24:39], v[176:179], v[76:79], v[24:39]
buffer_load_dwordx4 v[136:139], v3, s[4:7], s34 offen offset:2048 sc1
v_mfma_f32_32x32x16_bf16 v[40:55], v[180:183], v[76:79], v[40:55]
s_waitcnt vmcnt(7)
v_mfma_f32_32x32x16_bf16 v[24:39], v[184:187], v[80:83], v[24:39]
buffer_load_dwordx4 v[140:143], v3, s[4:7], s34 offen offset:2560 sc1
v_mfma_f32_32x32x16_bf16 v[40:55], v[188:191], v[80:83], v[40:55]
s_waitcnt vmcnt(7)
v_mfma_f32_32x32x16_bf16 v[24:39], v[192:195], v[112:115], v[24:39]
v_mfma_f32_32x32x16_bf16 v[40:55], v[196:199], v[112:115], v[40:55]
s_waitcnt vmcnt(6)
v_mfma_f32_32x32x16_bf16 v[24:39], v[200:203], v[116:119], v[24:39]
v_mfma_f32_32x32x16_bf16 v[40:55], v[204:207], v[116:119], v[40:55]
s_waitcnt vmcnt(5)
v_mfma_f32_32x32x16_bf16 v[24:39], v[208:211], v[120:123], v[24:39]
v_mfma_f32_32x32x16_bf16 v[40:55], v[212:215], v[120:123], v[40:55]
s_waitcnt vmcnt(4)
v_mfma_f32_32x32x16_bf16 v[24:39], v[216:219], v[124:127], v[24:39]
v_mfma_f32_32x32x16_bf16 v[40:55], v[220:223], v[124:127], v[40:55]
s_waitcnt vmcnt(3)
v_mfma_f32_32x32x16_bf16 v[24:39], v[224:227], v[128:131], v[24:39]
v_mfma_f32_32x32x16_bf16 v[40:55], v[228:231], v[128:131], v[40:55]
s_waitcnt vmcnt(2)
v_mfma_f32_32x32x16_bf16 v[24:39], v[232:235], v[132:135], v[24:39]
v_mfma_f32_32x32x16_bf16 v[40:55], v[236:239], v[132:135], v[40:55]
s_waitcnt vmcnt(12)
s_cmp_eq_u32 s16, 3
s_barrier
s_cbranch_scc1 SIG_92_s
SIG_92:
buffer_load_dword v67, v5, s[4:7], s68 offen offset:0 sc1
buffer_load_dword v67, v7, s[4:7], s54 offen offset:0 sc1
s_add_u32 s53, s53, 65536
s_add_u32 s68, s68, 65536
s_add_u32 s54, s54, 4096
s_waitcnt vmcnt(3)
v_mfma_f32_32x32x16_bf16 v[24:39], v[240:243], v[136:139], v[24:39]
v_mfma_f32_32x32x16_bf16 v[40:55], v[244:247], v[136:139], v[40:55]
s_waitcnt vmcnt(2)
v_mfma_f32_32x32x16_bf16 v[24:39], v[248:251], v[140:143], v[24:39]
v_mfma_f32_32x32x16_bf16 v[40:55], v[252:255], v[140:143], v[40:55]
s_nop 10
ds_write_b128 v8, v[24:27] offset:0
ds_write_b128 v8, v[28:31] offset:1024
ds_write_b128 v8, v[32:35] offset:8192
ds_write_b128 v8, v[36:39] offset:9216
ds_write_b128 v8, v[40:43] offset:16384
ds_write_b128 v8, v[44:47] offset:17408
ds_write_b128 v8, v[48:51] offset:24576
ds_write_b128 v8, v[52:55] offset:25600
s_waitcnt lgkmcnt(0)
s_barrier
ds_read_b128 v[24:27], v6 offset:0
ds_read_b128 v[28:31], v6 offset:1024
ds_read_b128 v[32:35], v6 offset:2048
ds_read_b128 v[36:39], v6 offset:3072
ds_read_b128 v[40:43], v6 offset:4096
ds_read_b128 v[44:47], v6 offset:5120
ds_read_b128 v[48:51], v6 offset:6144
ds_read_b128 v[52:55], v6 offset:7168
s_waitcnt vmcnt(13)
s_waitcnt lgkmcnt(4)
v_pk_add_f32 v[24:25], v[24:25], v[32:33]
v_pk_add_f32 v[26:27], v[26:27], v[34:35]
v_pk_add_f32 v[28:29], v[28:29], v[36:37]
v_pk_add_f32 v[30:31], v[30:31], v[38:39]
v_lshlrev_b32 v32, 16, v56
v_and_b32 v33, 0xffff0000, v56
v_lshlrev_b32 v34, 16, v57
v_and_b32 v35, 0xffff0000, v57
v_lshlrev_b32 v36, 16, v58
v_and_b32 v37, 0xffff0000, v58
v_lshlrev_b32 v38, 16, v59
v_and_b32 v39, 0xffff0000, v59
s_waitcnt lgkmcnt(0)
v_pk_add_f32 v[40:41], v[40:41], v[48:49]
v_pk_add_f32 v[24:25], v[24:25], v[32:33]
v_pk_add_f32 v[42:43], v[42:43], v[50:51]
v_pk_add_f32 v[26:27], v[26:27], v[34:35]
v_pk_add_f32 v[44:45], v[44:45], v[52:53]
v_pk_add_f32 v[28:29], v[28:29], v[36:37]
v_pk_add_f32 v[46:47], v[46:47], v[54:55]
v_pk_add_f32 v[30:31], v[30:31], v[38:39]
v_pk_add_f32 v[24:25], v[24:25], v[40:41]
v_pk_add_f32 v[26:27], v[26:27], v[42:43]
v_pk_add_f32 v[28:29], v[28:29], v[44:45]
v_pk_add_f32 v[30:31], v[30:31], v[46:47]
v_cvt_pk_bf16_f32 v32, v24, v25
v_cvt_pk_bf16_f32 v33, v26, v27
v_cvt_pk_bf16_f32 v34, v28, v29
v_cvt_pk_bf16_f32 v35, v30, v31
buffer_store_dwordx4 v[32:35], v5, s[64:67], s53 offen sc1
s_cmp_lg_u32 s18, 0
s_cbranch_scc1 M_FIN
v_pk_add_f32 v[40:41], v[24:25], v[26:27]
v_pk_mul_f32 v[42:43], v[24:25], v[24:25]
v_pk_add_f32 v[44:45], v[28:29], v[30:31]
v_pk_fma_f32 v[42:43], v[26:27], v[26:27], v[42:43]
v_pk_fma_f32 v[42:43], v[28:29], v[28:29], v[42:43]
v_pk_fma_f32 v[42:43], v[30:31], v[30:31], v[42:43]
v_pk_add_f32 v[40:41], v[40:41], v[44:45]
v_add_f32 v61, v42, v43
v_add_f32 v60, v40, v41
s_nop 1
v_permlane32_swap_b32 v60, v61
v_add_f32 v60, v60, v61
v_mov_b32 v61, v60
s_nop 1
v_permlane16_swap_b32 v60, v61
v_add_f32 v60, v60, v61
s_nop 1
v_add_f32_dpp v60, v60, v60 row_ror:8 row_mask:0xf bank_mask:0xf
buffer_store_dword v60, v7, s[4:7], s54 offen sc1
s_waitcnt vmcnt(0)
s_cmp_eq_u32 s16, 3
s_barrier
s_cbranch_scc1 SIG_93_s
SIG_93:
buffer_load_dword v67, v5, s[4:7], s68 offen offset:0 sc1
buffer_load_dword v67, v7, s[4:7], s54 offen offset:0 sc1
s_mov_b32 s18, 1
s_mov_b32 s20, s17
s_add_u32 s17, s17, 33554432
s_add_u32 s22, s22, 32768
s_mov_b32 s55, 8
s_add_u32 s28, s28, 131072
s_branch LAYER
WS_18_s:
s_add_u32 s23, s14, 3
s_and_b32 s23, s23, 3
s_lshl_b32 s23, s23, 13
s_add_u32 s23, s23, s57
s_add_u32 m0, s56, 57344
s_add_u32 s24, s23, 32768
buffer_load_dwordx4 v1, s[4:7], s24 offen offset:0 sc1 lds
buffer_load_dwordx4 v1, s[4:7], s24 offen offset:1024 sc1 lds
s_add_u32 m0, s56, 90112
s_add_u32 s24, s23, 65536
buffer_load_dwordx4 v1, s[4:7], s24 offen offset:0 sc1 lds
buffer_load_dwordx4 v1, s[4:7], s24 offen offset:1024 sc1 lds
ds_read_b128 a[64:67], v120 offset:8192
ds_read_b128 a[68:71], v120 offset:9216
ds_read_b128 a[72:75], v120 offset:40960
ds_read_b128 a[76:79], v120 offset:41984
s_waitcnt lgkmcnt(0)
v_mfma_f32_32x32x16_bf16 a[16:31], a[80:83], a[64:67], a[16:31]
v_mfma_f32_32x32x16_bf16 a[16:31], a[80:83], a[68:71], a[16:31]
v_mfma_f32_32x32x16_bf16 a[32:47], a[80:83], a[72:75], a[32:47]
v_mfma_f32_32x32x16_bf16 a[32:47], a[80:83], a[76:79], a[32:47]
s_barrier
s_branch WS_18
WS_19_s:
s_add_u32 m0, s58, 0
s_lshl_b32 s24, s14, 13
s_add_u32 s24, s24, m0
s_and_b32 s24, s24, 32767
s_add_u32 s24, s24, s59
buffer_load_dwordx4 v1, s[4:7], s24 offen offset:0 sc1 lds
buffer_load_dwordx4 v1, s[4:7], s24 offen offset:1024 sc1 lds
buffer_load_dwordx4 v1, s[4:7], s24 offen offset:2048 sc1 lds
buffer_load_dwordx4 v1, s[4:7], s24 offen offset:3072 sc1 lds
ds_read_b128 a[64:67], v120 offset:16384
ds_read_b128 a[68:71], v120 offset:17408
ds_read_b128 a[72:75], v120 offset:49152
ds_read_b128 a[76:79], v120 offset:50176
s_waitcnt lgkmcnt(0)
v_mfma_f32_32x32x16_bf16 a[16:31], a[80:83], a[64:67], a[16:31]
v_mfma_f32_32x32x16_bf16 a[16:31], a[80:83], a[68:71], a[16:31]
v_mfma_f32_32x32x16_bf16 a[32:47], a[80:83], a[72:75], a[32:47]
v_mfma_f32_32x32x16_bf16 a[32:47], a[80:83], a[76:79], a[32:47]
s_barrier
s_cmp_lg_u32 s16, 3
s_cbranch_scc1 WS_19
s_add_u32 s24, s22, 20480
s_mov_b64 exec, 1
v_mov_b32 v111, 1
buffer_atomic_add v111, off, s[4:7], s24 sc0
s_mov_b64 exec, -1
s_branch WS_19
WS_20_s:
s_add_u32 m0, s58, 16384
s_lshl_b32 s24, s14, 13
s_add_u32 s24, s24, m0
s_and_b32 s24, s24, 32767
s_add_u32 s24, s24, s59
buffer_load_dwordx4 v1, s[4:7], s24 offen offset:0 sc1 lds
buffer_load_dwordx4 v1, s[4:7], s24 offen offset:1024 sc1 lds
buffer_load_dwordx4 v1, s[4:7], s24 offen offset:2048 sc1 lds
buffer_load_dwordx4 v1, s[4:7], s24 offen offset:3072 sc1 lds
ds_read_b128 a[64:67], v120 offset:24576
ds_read_b128 a[68:71], v120 offset:25600
ds_read_b128 a[72:75], v120 offset:57344
ds_read_b128 a[76:79], v120 offset:58368
s_waitcnt lgkmcnt(0)
v_mfma_f32_32x32x16_bf16 a[16:31], a[80:83], a[64:67], a[16:31]
v_mfma_f32_32x32x16_bf16 a[16:31], a[80:83], a[68:71], a[16:31]
v_mfma_f32_32x32x16_bf16 a[32:47], a[80:83], a[72:75], a[32:47]
v_mfma_f32_32x32x16_bf16 a[32:47], a[80:83], a[76:79], a[32:47]
s_barrier
s_branch WS_20
WS_21_s:
s_waitcnt vmcnt(0)
ds_read_b128 a[64:67], v121 offset:0
ds_read_b128 a[68:71], v121 offset:1024
ds_read_b128 a[72:75], v121 offset:2048
ds_read_b128 a[76:79], v121 offset:3072
s_waitcnt lgkmcnt(0)
v_mfma_f32_32x32x16_bf16 a[0:15], a[80:83], a[64:67], 0
v_mfma_f32_32x32x16_bf16 a[0:15], a[80:83], a[68:71], a[0:15]
v_mfma_f32_32x32x16_bf16 a[0:15], a[80:83], a[72:75], a[0:15]
v_mfma_f32_32x32x16_bf16 a[0:15], a[80:83], a[76:79], a[0:15]
ds_read_b128 a[64:67], v121 offset:16384
ds_read_b128 a[68:71], v121 offset:17408
ds_read_b128 a[72:75], v121 offset:18432
ds_read_b128 a[76:79], v121 offset:19456
s_waitcnt lgkmcnt(0)
v_mfma_f32_32x32x16_bf16 a[0:15], a[80:83], a[64:67], a[0:15]
v_mfma_f32_32x32x16_bf16 a[0:15], a[80:83], a[68:71], a[0:15]
v_mfma_f32_32x32x16_bf16 a[0:15], a[80:83], a[72:75], a[0:15]
v_mfma_f32_32x32x16_bf16 a[0:15], a[80:83], a[76:79], a[0:15]
v_lshlrev_b32 v120, 2, v0
v_add_u32 v120, 147456, v120
s_nop 7
s_nop 1
v_accvgpr_read_b32 v121, a0
v_accvgpr_read_b32 v122, a16
v_accvgpr_read_b32 v123, a32
s_mov_b32 exec_hi, 0
ds_add_f32 v120, v121 offset:0
ds_add_f32 v120, v122 offset:128
ds_add_f32 v120, v123 offset:256
s_mov_b64 exec, -1
s_waitcnt lgkmcnt(0)
s_barrier
s_cmp_lg_u32 s16, 3
s_cbranch_scc1 WS_21
v_readfirstlane_b32 s23, v111
s_nop 0
s_cmp_lg_u32 s23, 15
s_cbranch_scc1 WS_21
v_lshlrev_b32 v120, 7, v0
v_mov_b32 v111, 1
s_mov_b32 s24, 22528
s_mov_b64 exec, 0xffff
buffer_atomic_add v111, v120, s[4:7], s24 offen
s_mov_b64 exec, -1
s_branch WS_21
FIX_30_s:
s_nop 7
v_mov_b32 v112, 0xf149f2ca
v_mov_b32 v113, 0xf149f2ca
v_mov_b32 v114, 0xf149f2ca
v_mov_b32 v115, 0xf149f2ca
v_mov_b32 v116, 0xf149f2ca
v_mov_b32 v117, 0xf149f2ca
v_mov_b32 v118, 0xf149f2ca
v_mov_b32 v119, 0xf149f2ca
v_mov_b32 v120, 0xf149f2ca
v_mov_b32 v121, 0xf149f2ca
v_mov_b32 v122, 0xf149f2ca
v_mov_b32 v123, 0xf149f2ca
v_mov_b32 v124, 0xf149f2ca
v_mov_b32 v125, 0xf149f2ca
v_mov_b32 v126, 0xf149f2ca
v_mov_b32 v127, 0xf149f2ca
s_nop 1
s_branch FIX_30
FIX_32_s:
s_nop 7
v_mov_b32 v112, 0xf149f2ca
v_mov_b32 v113, 0xf149f2ca
v_mov_b32 v114, 0xf149f2ca
v_mov_b32 v115, 0xf149f2ca
v_mov_b32 v116, 0xf149f2ca
v_mov_b32 v117, 0xf149f2ca
v_mov_b32 v118, 0xf149f2ca
v_mov_b32 v119, 0xf149f2ca
v_mov_b32 v120, 0xf149f2ca
v_mov_b32 v121, 0xf149f2ca
v_mov_b32 v122, 0xf149f2ca
v_mov_b32 v123, 0xf149f2ca
v_mov_b32 v124, 0xf149f2ca
v_mov_b32 v125, 0xf149f2ca
v_mov_b32 v126, 0xf149f2ca
v_mov_b32 v127, 0xf149f2ca
s_nop 1
s_branch FIX_32
GW_33_s:
v_accvgpr_write_b32 a144, s46
v_accvgpr_write_b32 a145, s46
v_accvgpr_write_b32 a146, s46
v_accvgpr_write_b32 a147, s46
buffer_load_dwordx4 a[0:3], v1, s[4:7], s36 offen offset:0 sc1
buffer_load_dwordx4 a[4:7], v1, s[4:7], s37 offen offset:1024 sc1
s_branch GW_33
FIX_34_s:
s_nop 7
v_mov_b32 v112, 0xf149f2ca
v_mov_b32 v113, 0xf149f2ca
v_mov_b32 v114, 0xf149f2ca
v_mov_b32 v115, 0xf149f2ca
v_mov_b32 v116, 0xf149f2ca
v_mov_b32 v117, 0xf149f2ca
v_mov_b32 v118, 0xf149f2ca
v_mov_b32 v119, 0xf149f2ca
v_mov_b32 v120, 0xf149f2ca
v_mov_b32 v121, 0xf149f2ca
v_mov_b32 v122, 0xf149f2ca
v_mov_b32 v123, 0xf149f2ca
v_mov_b32 v124, 0xf149f2ca
v_mov_b32 v125, 0xf149f2ca
v_mov_b32 v126, 0xf149f2ca
v_mov_b32 v127, 0xf149f2ca
s_nop 1
s_branch FIX_34
GW_35_s:
buffer_load_dwordx4 a[8:11], v1, s[4:7], s36 offen offset:2048 sc1
buffer_load_dwordx4 a[12:15], v1, s[4:7], s37 offen offset:3072 sc1
s_add_u32 s36, s36, 4096
s_add_u32 s37, s37, 4096
s_branch GW_35
FIX_36_s:
s_nop 7
v_mov_b32 v112, 0xf149f2ca
v_mov_b32 v113, 0xf149f2ca
v_mov_b32 v114, 0xf149f2ca
v_mov_b32 v115, 0xf149f2ca
v_mov_b32 v116, 0xf149f2ca
v_mov_b32 v117, 0xf149f2ca
v_mov_b32 v118, 0xf149f2ca
v_mov_b32 v119, 0xf149f2ca
v_mov_b32 v120, 0xf149f2ca
v_mov_b32 v121, 0xf149f2ca
v_mov_b32 v122, 0xf149f2ca
v_mov_b32 v123, 0xf149f2ca
v_mov_b32 v124, 0xf149f2ca
v_mov_b32 v125, 0xf149f2ca
v_mov_b32 v126, 0xf149f2ca
v_mov_b32 v127, 0xf149f2ca
s_nop 1
s_branch FIX_36
GW_37_s:
buffer_load_dwordx4 a[16:19], v1, s[4:7], s36 offen offset:0 sc1
buffer_load_dwordx4 a[20:23], v1, s[4:7], s37 offen offset:1024 sc1
s_branch GW_37
GW_38_s:
buffer_load_dwordx4 a[24:27], v1, s[4:7], s36 offen offset:2048 sc1
buffer_load_dwordx4 a[28:31], v1, s[4:7], s37 offen offset:3072 sc1
s_add_u32 s36, s36, 4096
s_add_u32 s37, s37, 4096
s_branch GW_38
FIX_39_s:
s_nop 7
v_mov_b32 v112, 0xf149f2ca
v_mov_b32 v113, 0xf149f2ca
v_mov_b32 v114, 0xf149f2ca
v_mov_b32 v115, 0xf149f2ca
v_mov_b32 v116, 0xf149f2ca
v_mov_b32 v117, 0xf149f2ca
v_mov_b32 v118, 0xf149f2ca
v_mov_b32 v119, 0xf149f2ca
v_mov_b32 v120, 0xf149f2ca
v_mov_b32 v121, 0xf149f2ca
v_mov_b32 v122, 0xf149f2ca
v_mov_b32 v123, 0xf149f2ca
v_mov_b32 v124, 0xf149f2ca
v_mov_b32 v125, 0xf149f2ca
v_mov_b32 v126, 0xf149f2ca
v_mov_b32 v127, 0xf149f2ca
s_nop 1
s_branch FIX_39
GW_40_s:
buffer_load_dwordx4 a[32:35], v1, s[4:7], s36 offen offset:0 sc1
buffer_load_dwordx4 a[36:39], v1, s[4:7], s37 offen offset:1024 sc1
s_branch GW_40
FIX_41_s:
s_nop 7
v_mov_b32 v112, 0xf149f2ca
v_mov_b32 v113, 0xf149f2ca
v_mov_b32 v114, 0xf149f2ca
v_mov_b32 v115, 0xf149f2ca
v_mov_b32 v116, 0xf149f2ca
v_mov_b32 v117, 0xf149f2ca
v_mov_b32 v118, 0xf149f2ca
v_mov_b32 v119, 0xf149f2ca
v_mov_b32 v120, 0xf149f2ca
v_mov_b32 v121, 0xf149f2ca
v_mov_b32 v122, 0xf149f2ca
v_mov_b32 v123, 0xf149f2ca
v_mov_b32 v124, 0xf149f2ca
v_mov_b32 v125, 0xf149f2ca
v_mov_b32 v126, 0xf149f2ca
v_mov_b32 v127, 0xf149f2ca
s_nop 1
s_branch FIX_41
GW_42_s:
buffer_load_dwordx4 a[40:43], v1, s[4:7], s36 offen offset:2048 sc1
buffer_load_dwordx4 a[44:47], v1, s[4:7], s37 offen offset:3072 sc1
s_add_u32 s36, s36, 4096
s_add_u32 s37, s37, 4096
s_branch GW_42
GW_43_s:
s_waitcnt vmcnt(22)
v_mfma_f32_32x32x16_bf16 a[128:143], a[0:3], a[144:147], 0
buffer_load_dwordx4 a[48:51], v1, s[4:7], s36 offen offset:0 sc1
buffer_load_dwordx4 a[52:55], v1, s[4:7], s37 offen offset:1024 sc1
v_mfma_f32_32x32x16_bf16 a[128:143], a[4:7], a[144:147], a[128:143]
s_branch GW_43
FIX_44_s:
s_nop 7
v_mov_b32 v112, 0xf149f2ca
v_mov_b32 v113, 0xf149f2ca
v_mov_b32 v114, 0xf149f2ca
v_mov_b32 v115, 0xf149f2ca
v_mov_b32 v116, 0xf149f2ca
v_mov_b32 v117, 0xf149f2ca
v_mov_b32 v118, 0xf149f2ca
v_mov_b32 v119, 0xf149f2ca
v_mov_b32 v120, 0xf149f2ca
v_mov_b32 v121, 0xf149f2ca
v_mov_b32 v122, 0xf149f2ca
v_mov_b32 v123, 0xf149f2ca
v_mov_b32 v124, 0xf149f2ca
v_mov_b32 v125, 0xf149f2ca
v_mov_b32 v126, 0xf149f2ca
v_mov_b32 v127, 0xf149f2ca
s_nop 1
s_branch FIX_44
GW_45_s:
s_waitcnt vmcnt(22)
v_mfma_f32_32x32x16_bf16 a[128:143], a[8:11], a[144:147], a[128:143]
buffer_load_dwordx4 a[56:59], v1, s[4:7], s36 offen offset:2048 sc1
buffer_load_dwordx4 a[60:63], v1, s[4:7], s37 offen offset:3072 sc1
s_add_u32 s36, s36, 4096
s_add_u32 s37, s37, 4096
v_mfma_f32_32x32x16_bf16 a[128:143], a[12:15], a[144:147], a[128:143]
s_branch GW_45
FIX_46_s:
s_nop 7
v_mov_b32 v112, 0xf149f2ca
v_mov_b32 v113, 0xf149f2ca
v_mov_b32 v114, 0xf149f2ca
v_mov_b32 v115, 0xf149f2ca
v_mov_b32 v116, 0xf149f2ca
v_mov_b32 v117, 0xf149f2ca
v_mov_b32 v118, 0xf149f2ca
v_mov_b32 v119, 0xf149f2ca
v_mov_b32 v120, 0xf149f2ca
v_mov_b32 v121, 0xf149f2ca
v_mov_b32 v122, 0xf149f2ca
v_mov_b32 v123, 0xf149f2ca
v_mov_b32 v124, 0xf149f2ca
v_mov_b32 v125, 0xf149f2ca
v_mov_b32 v126, 0xf149f2ca
v_mov_b32 v127, 0xf149f2ca
s_nop 1
s_branch FIX_46
GW_47_s:
s_waitcnt vmcnt(22)
v_mfma_f32_32x32x16_bf16 a[128:143], a[16:19], a[144:147], a[128:143]
buffer_load_dwordx4 a[64:67], v1, s[4:7], s36 offen offset:0 sc1
buffer_load_dwordx4 a[68:71], v1, s[4:7], s37 offen offset:1024 sc1
v_mfma_f32_32x32x16_bf16 a[128:143], a[20:23], a[144:147], a[128:143]
s_branch GW_47
GW_48_s:
s_waitcnt vmcnt(22)
v_mfma_f32_32x32x16_bf16 a[128:143], a[24:27], a[144:147], a[128:143]
buffer_load_dwordx4 a[72:75], v1, s[4:7], s36 offen offset:2048 sc1
buffer_load_dwordx4 a[76:79], v1, s[4:7], s37 offen offset:3072 sc1
s_add_u32 s36, s36, 4096
s_add_u32 s37, s37, 4096
v_mfma_f32_32x32x16_bf16 a[128:143], a[28:31], a[144:147], a[128:143]
s_branch GW_48
GW_49_s:
s_waitcnt vmcnt(22)
v_mfma_f32_32x32x16_bf16 a[128:143], a[32:35], a[144:147], a[128:143]
buffer_load_dwordx4 a[80:83], v1, s[4:7], s36 offen offset:0 sc1
buffer_load_dwordx4 a[84:87], v1, s[4:7], s37 offen offset:1024 sc1
v_mfma_f32_32x32x16_bf16 a[128:143], a[36:39], a[144:147], a[128:143]
s_branch GW_49
FIX_52_s:
s_nop 7
v_mov_b32 v112, 0xf149f2ca
v_mov_b32 v113, 0xf149f2ca
v_mov_b32 v114, 0xf149f2ca
v_mov_b32 v115, 0xf149f2ca
v_mov_b32 v116, 0xf149f2ca
v_mov_b32 v117, 0xf149f2ca
v_mov_b32 v118, 0xf149f2ca
v_mov_b32 v119, 0xf149f2ca
v_mov_b32 v120, 0xf149f2ca
v_mov_b32 v121, 0xf149f2ca
v_mov_b32 v122, 0xf149f2ca
v_mov_b32 v123, 0xf149f2ca
v_mov_b32 v124, 0xf149f2ca
v_mov_b32 v125, 0xf149f2ca
v_mov_b32 v126, 0xf149f2ca
v_mov_b32 v127, 0xf149f2ca
s_nop 1
s_branch FIX_52
FIX_54_s:
s_nop 7
v_mov_b32 v112, 0xf149f2ca
v_mov_b32 v113, 0xf149f2ca
v_mov_b32 v114, 0xf149f2ca
v_mov_b32 v115, 0xf149f2ca
v_mov_b32 v116, 0xf149f2ca
v_mov_b32 v117, 0xf149f2ca
v_mov_b32 v118, 0xf149f2ca
v_mov_b32 v119, 0xf149f2ca
v_mov_b32 v120, 0xf149f2ca
v_mov_b32 v121, 0xf149f2ca
v_mov_b32 v122, 0xf149f2ca
v_mov_b32 v123, 0xf149f2ca
v_mov_b32 v124, 0xf149f2ca
v_mov_b32 v125, 0xf149f2ca
v_mov_b32 v126, 0xf149f2ca
v_mov_b32 v127, 0xf149f2ca
s_nop 1
s_branch FIX_54
SIG_55_s:
s_add_u32 s23, s55, 1
s_mov_b64 exec, 1
v_mov_b32 v181, s23
buffer_store_dword v181, off, s[4:7], s47
s_add_u32 s24, s22, 0
v_mov_b32 v181, 1
buffer_atomic_add v181, off, s[4:7], s24
s_mov_b64 exec, -1
s_branch SIG_55
GW_56_s:
s_waitcnt vmcnt(22)
v_mfma_f32_32x32x16_bf16 a[128:143], a[40:43], a[144:147], a[128:143]
buffer_load_dwordx4 a[88:91], v1, s[4:7], s36 offen offset:2048 sc1
buffer_load_dwordx4 a[92:95], v1, s[4:7], s37 offen offset:3072 sc1
s_add_u32 s36, s36, 4096
s_add_u32 s37, s37, 4096
v_mfma_f32_32x32x16_bf16 a[128:143], a[44:47], a[144:147], a[128:143]
s_branch GW_56
FIX_57_s:
s_nop 7
v_mov_b32 v112, 0xf149f2ca
v_mov_b32 v113, 0xf149f2ca
v_mov_b32 v114, 0xf149f2ca
v_mov_b32 v115, 0xf149f2ca
v_mov_b32 v116, 0xf149f2ca
v_mov_b32 v117, 0xf149f2ca
v_mov_b32 v118, 0xf149f2ca
v_mov_b32 v119, 0xf149f2ca
v_mov_b32 v120, 0xf149f2ca
v_mov_b32 v121, 0xf149f2ca
v_mov_b32 v122, 0xf149f2ca
v_mov_b32 v123, 0xf149f2ca
v_mov_b32 v124, 0xf149f2ca
v_mov_b32 v125, 0xf149f2ca
v_mov_b32 v126, 0xf149f2ca
v_mov_b32 v127, 0xf149f2ca
s_nop 1
s_branch FIX_57
GW_58_s:
s_waitcnt vmcnt(22)
v_mfma_f32_32x32x16_bf16 a[128:143], a[48:51], a[144:147], a[128:143]
buffer_load_dwordx4 a[96:99], v1, s[4:7], s36 offen offset:0 sc1
buffer_load_dwordx4 a[100:103], v1, s[4:7], s37 offen offset:1024 sc1
v_mfma_f32_32x32x16_bf16 a[128:143], a[52:55], a[144:147], a[128:143]
s_branch GW_58
FIX_59_s:
s_nop 7
v_mov_b32 v112, 0xf149f2ca
v_mov_b32 v113, 0xf149f2ca
v_mov_b32 v114, 0xf149f2ca
v_mov_b32 v115, 0xf149f2ca
v_mov_b32 v116, 0xf149f2ca
v_mov_b32 v117, 0xf149f2ca
v_mov_b32 v118, 0xf149f2ca
v_mov_b32 v119, 0xf149f2ca
v_mov_b32 v120, 0xf149f2ca
v_mov_b32 v121, 0xf149f2ca
v_mov_b32 v122, 0xf149f2ca
v_mov_b32 v123, 0xf149f2ca
v_mov_b32 v124, 0xf149f2ca
v_mov_b32 v125, 0xf149f2ca
v_mov_b32 v126, 0xf149f2ca
v_mov_b32 v127, 0xf149f2ca
s_nop 1
s_branch FIX_59
GW_60_s:
s_waitcnt vmcnt(22)
v_mfma_f32_32x32x16_bf16 a[128:143], a[56:59], a[144:147], a[128:143]
buffer_load_dwordx4 a[104:107], v1, s[4:7], s36 offen offset:2048 sc1
buffer_load_dwordx4 a[108:111], v1, s[4:7], s37 offen offset:3072 sc1
s_add_u32 s36, s36, 4096
s_add_u32 s37, s37, 4096
v_mfma_f32_32x32x16_bf16 a[128:143], a[60:63], a[144:147], a[128:143]
s_branch GW_60
GW_61_s:
s_waitcnt vmcnt(22)
v_mfma_f32_32x32x16_bf16 a[128:143], a[64:67], a[144:147], a[128:143]
buffer_load_dwordx4 a[112:115], v1, s[4:7], s36 offen offset:0 sc1
buffer_load_dwordx4 a[116:119], v1, s[4:7], s37 offen offset:1024 sc1
v_mfma_f32_32x32x16_bf16 a[128:143], a[68:71], a[144:147], a[128:143]
s_branch GW_61
FIX_62_s:
s_nop 7
v_mov_b32 v112, 0xf149f2ca
v_mov_b32 v113, 0xf149f2ca
v_mov_b32 v114, 0xf149f2ca
v_mov_b32 v115, 0xf149f2ca
v_mov_b32 v116, 0xf149f2ca
v_mov_b32 v117, 0xf149f2ca
v_mov_b32 v118, 0xf149f2ca
v_mov_b32 v119, 0xf149f2ca
v_mov_b32 v120, 0xf149f2ca
v_mov_b32 v121, 0xf149f2ca
v_mov_b32 v122, 0xf149f2ca
v_mov_b32 v123, 0xf149f2ca
v_mov_b32 v124, 0xf149f2ca
v_mov_b32 v125, 0xf149f2ca
v_mov_b32 v126, 0xf149f2ca
v_mov_b32 v127, 0xf149f2ca
s_nop 1
s_branch FIX_62
GW_63_s:
s_waitcnt vmcnt(22)
v_mfma_f32_32x32x16_bf16 a[128:143], a[72:75], a[144:147], a[128:143]
buffer_load_dwordx4 a[120:123], v1, s[4:7], s36 offen offset:2048 sc1
buffer_load_dwordx4 a[124:127], v1, s[4:7], s37 offen offset:3072 sc1
s_add_u32 s36, s36, 4096
s_add_u32 s37, s37, 4096
v_mfma_f32_32x32x16_bf16 a[128:143], a[76:79], a[144:147], a[128:143]
s_branch GW_63
FIX_64_s:
s_nop 7
v_mov_b32 v112, 0xf149f2ca
v_mov_b32 v113, 0xf149f2ca
v_mov_b32 v114, 0xf149f2ca
v_mov_b32 v115, 0xf149f2ca
v_mov_b32 v116, 0xf149f2ca
v_mov_b32 v117, 0xf149f2ca
v_mov_b32 v118, 0xf149f2ca
v_mov_b32 v119, 0xf149f2ca
v_mov_b32 v120, 0xf149f2ca
v_mov_b32 v121, 0xf149f2ca
v_mov_b32 v122, 0xf149f2ca
v_mov_b32 v123, 0xf149f2ca
v_mov_b32 v124, 0xf149f2ca
v_mov_b32 v125, 0xf149f2ca
v_mov_b32 v126, 0xf149f2ca
v_mov_b32 v127, 0xf149f2ca
s_nop 1
s_branch FIX_64
GW_65_s:
s_waitcnt vmcnt(22)
v_mfma_f32_32x32x16_bf16 a[128:143], a[80:83], a[144:147], a[128:143]
s_add_u32 s39, s38, 12288
buffer_load_dwordx4 a[152:155], v188, s[4:7], s39 offen offset:0 sc1
buffer_load_dwordx4 a[156:159], v188, s[4:7], s39 offen offset:2048 sc1
v_mfma_f32_32x32x16_bf16 a[128:143], a[84:87], a[144:147], a[128:143]
s_branch GW_65
GW_66_s:
s_waitcnt vmcnt(20)
v_mfma_f32_32x32x16_bf16 a[128:143], a[88:91], a[144:147], a[128:143]
s_add_u32 s39, s38, 16384
buffer_load_dwordx4 a[160:163], v188, s[4:7], s39 offen offset:0 sc1
buffer_load_dwordx4 a[164:167], v188, s[4:7], s39 offen offset:2048 sc1
v_mfma_f32_32x32x16_bf16 a[128:143], a[92:95], a[144:147], a[128:143]
s_branch GW_66
FIX_67_s:
s_nop 7
v_mov_b32 v112, 0xf149f2ca
v_mov_b32 v113, 0xf149f2ca
v_mov_b32 v114, 0xf149f2ca
v_mov_b32 v115, 0xf149f2ca
v_mov_b32 v116, 0xf149f2ca
v_mov_b32 v117, 0xf149f2ca
v_mov_b32 v118, 0xf149f2ca
v_mov_b32 v119, 0xf149f2ca
v_mov_b32 v120, 0xf149f2ca
v_mov_b32 v121, 0xf149f2ca
v_mov_b32 v122, 0xf149f2ca
v_mov_b32 v123, 0xf149f2ca
v_mov_b32 v124, 0xf149f2ca
v_mov_b32 v125, 0xf149f2ca
v_mov_b32 v126, 0xf149f2ca
v_mov_b32 v127, 0xf149f2ca
s_nop 1
s_branch FIX_67
GW_68_s:
s_waitcnt vmcnt(18)
v_mfma_f32_32x32x16_bf16 a[128:143], a[96:99], a[144:147], a[128:143]
s_add_u32 s39, s38, 20480
buffer_load_dwordx4 a[168:171], v188, s[4:7], s39 offen offset:0 sc1
buffer_load_dwordx4 a[172:175], v188, s[4:7], s39 offen offset:2048 sc1
v_mfma_f32_32x32x16_bf16 a[128:143], a[100:103], a[144:147], a[128:143]
s_branch GW_68
GW_69_s:
s_waitcnt vmcnt(16)
v_mfma_f32_32x32x16_bf16 a[128:143], a[104:107], a[144:147], a[128:143]
s_add_u32 s39, s38, 24576
buffer_load_dwordx4 a[176:179], v188, s[4:7], s39 offen offset:0 sc1
buffer_load_dwordx4 a[180:183], v188, s[4:7], s39 offen offset:2048 sc1
v_mfma_f32_32x32x16_bf16 a[128:143], a[108:111], a[144:147], a[128:143]
s_branch GW_69
AP_70_s:
s_add_u32 s24, s22, 0
s_add_u32 s23, s55, 1
POLL_94:
s_mov_b64 exec, 0xffff
buffer_load_dword v181, v1, s[4:7], s3 offen sc1
s_mov_b64 exec, -1
s_waitcnt vmcnt(0)
v_cmp_gt_u32 s[96:97], s23, v181
s_nop 0
s_and_b32 s96, s96, 0xffff
s_cbranch_scc0 PX_95
s_sub_u32 s21, s21, 1
s_cbranch_scc1 PX_95_t
s_and_b32 s96, s21, 15
s_cbranch_scc1 POLL_94
buffer_load_dword v181, off, s[4:7], s24 sc1
s_waitcnt vmcnt(0)
v_readfirstlane_b32 s96, v181
s_nop 0
s_cmp_lt_u32 s96, 16
s_cbranch_scc1 POLL_94
s_branch PX_95
PX_95_t:
s_mov_b32 s21, 0
PX_95:
s_branch AP_70
FIX_71_s:
s_nop 7
v_mov_b32 v112, 0xf149f2ca
v_mov_b32 v113, 0xf149f2ca
v_mov_b32 v114, 0xf149f2ca
v_mov_b32 v115, 0xf149f2ca
v_mov_b32 v116, 0xf149f2ca
v_mov_b32 v117, 0xf149f2ca
v_mov_b32 v118, 0xf149f2ca
v_mov_b32 v119, 0xf149f2ca
v_mov_b32 v120, 0xf149f2ca
v_mov_b32 v121, 0xf149f2ca
v_mov_b32 v122, 0xf149f2ca
v_mov_b32 v123, 0xf149f2ca
v_mov_b32 v124, 0xf149f2ca
v_mov_b32 v125, 0xf149f2ca
v_mov_b32 v126, 0xf149f2ca
v_mov_b32 v127, 0xf149f2ca
s_nop 1
s_branch FIX_71
GW_72_s:
s_waitcnt vmcnt(14)
v_mfma_f32_32x32x16_bf16 a[128:143], a[112:115], a[144:147], a[128:143]
s_add_u32 s39, s38, 28672
buffer_load_dwordx4 a[184:187], v188, s[4:7], s39 offen offset:0 sc1
buffer_load_dwordx4 a[188:191], v188, s[4:7], s39 offen offset:2048 sc1
v_mfma_f32_32x32x16_bf16 a[128:143], a[116:119], a[144:147], a[128:143]
s_branch GW_72
SIG_79_s:
s_add_u32 s23, s55, 2
s_mov_b64 exec, 1
v_mov_b32 v111, s23
buffer_store_dword v111, off, s[4:7], s47
s_add_u32 s24, s22, 4096
v_mov_b32 v111, 1
buffer_atomic_add v111, off, s[4:7], s24
s_mov_b64 exec, -1
s_branch SIG_79
SIG_86_s:
s_add_u32 s23, s55, 3
s_mov_b64 exec, 1
v_mov_b32 v67, s23
buffer_store_dword v67, off, s[4:7], s47
s_add_u32 s24, s22, 6144
v_mov_b32 v67, 1
buffer_atomic_add v67, off, s[4:7], s24
s_mov_b64 exec, -1
s_branch SIG_86
AP_87_s:
s_add_u32 s24, s22, 6144
s_add_u32 s23, s55, 3
POLL_96:
s_mov_b64 exec, 0xffff
buffer_load_dword v67, v1, s[4:7], s3 offen sc1
s_mov_b64 exec, -1
s_waitcnt vmcnt(0)
v_cmp_gt_u32 s[96:97], s23, v67
s_nop 0
s_and_b32 s96, s96, 0xffff
s_cbranch_scc0 PX_97
s_sub_u32 s21, s21, 1
s_cbranch_scc1 PX_97_t
s_and_b32 s96, s21, 15
s_cbranch_scc1 POLL_96
buffer_load_dword v67, off, s[4:7], s24 sc1
s_waitcnt vmcnt(0)
v_readfirstlane_b32 s96, v67
s_nop 0
s_cmp_lt_u32 s96, 16
s_cbranch_scc1 POLL_96
s_branch PX_97
PX_97_t:
s_mov_b32 s21, 0
PX_97:
s_branch AP_87
SIG_88_s:
s_add_u32 s23, s55, 4
s_mov_b64 exec, 1
v_mov_b32 v67, s23
buffer_store_dword v67, off, s[4:7], s47
s_add_u32 s24, s22, 8192
v_mov_b32 v67, 1
buffer_atomic_add v67, off, s[4:7], s24
s_mov_b64 exec, -1
s_branch SIG_88
AP_89_s:
s_add_u32 s24, s22, 8192
s_add_u32 s23, s55, 4
POLL_98:
s_mov_b64 exec, 0xffff
buffer_load_dword v67, v1, s[4:7], s3 offen sc1
s_mov_b64 exec, -1
s_waitcnt vmcnt(0)
v_cmp_gt_u32 s[96:97], s23, v67
s_nop 0
s_and_b32 s96, s96, 0xffff
s_cbranch_scc0 PX_99
s_sub_u32 s21, s21, 1
s_cbranch_scc1 PX_99_t
s_and_b32 s96, s21, 15
s_cbranch_scc1 POLL_98
buffer_load_dword v67, off, s[4:7], s24 sc1
s_waitcnt vmcnt(0)
v_readfirstlane_b32 s96, v67
s_nop 0
s_cmp_lt_u32 s96, 16
s_cbranch_scc1 POLL_98
s_branch PX_99
PX_99_t:
s_mov_b32 s21, 0
PX_99:
s_branch AP_89
SIG_90_s:
s_add_u32 s23, s55, 5
s_mov_b64 exec, 1
v_mov_b32 v67, s23
buffer_store_dword v67, off, s[4:7], s47
s_add_u32 s24, s22, 10240
v_mov_b32 v67, 1
buffer_atomic_add v67, off, s[4:7], s24
s_mov_b64 exec, -1
s_branch SIG_90
AP_91_s:
s_add_u32 s24, s22, 10240
s_add_u32 s23, s55, 5
POLL_100:
s_mov_b64 exec, 0xffff
buffer_load_dword v67, v1, s[4:7], s3 offen sc1
s_mov_b64 exec, -1
s_waitcnt vmcnt(0)
v_cmp_gt_u32 s[96:97], s23, v67
s_nop 0
s_and_b32 s96, s96, 0xffff
s_cbranch_scc0 PX_101
s_sub_u32 s21, s21, 1
s_cbranch_scc1 PX_101_t
s_and_b32 s96, s21, 15
s_cbranch_scc1 POLL_100
buffer_load_dword v67, off, s[4:7], s24 sc1
s_waitcnt vmcnt(0)
v_readfirstlane_b32 s96, v67
s_nop 0
s_cmp_lt_u32 s96, 16
s_cbranch_scc1 POLL_100
s_branch PX_101
PX_101_t:
s_mov_b32 s21, 0
PX_101:
s_branch AP_91
SIG_92_s:
s_add_u32 s23, s55, 6
s_mov_b64 exec, 1
v_mov_b32 v67, s23
buffer_store_dword v67, off, s[4:7], s47
s_add_u32 s24, s22, 12288
v_mov_b32 v67, 1
buffer_atomic_add v67, off, s[4:7], s24
s_mov_b64 exec, -1
s_branch SIG_92
SIG_93_s:
s_add_u32 s23, s55, 7
s_mov_b64 exec, 1
v_mov_b32 v67, s23
buffer_store_dword v67, off, s[4:7], s47
s_add_u32 s24, s22, 14336
v_mov_b32 v67, 1
buffer_atomic_add v67, off, s[4:7], s24
s_mov_b64 exec, -1
s_branch SIG_93
M_FIN:
M_END:
CODE_END:
s_endpgm
.section .rodata,"a"
.p2align 6
.amdhsa_kernel interleave_layers__sliding_block__glu_gated_swiglu__prompt_kernel
  .amdhsa_next_free_vgpr 512
  .amdhsa_next_free_sgpr 102
  .amdhsa_accum_offset 256
  .amdhsa_group_segment_fixed_size 0
  .amdhsa_kernarg_size 80
  .amdhsa_user_sgpr_count 2
  .amdhsa_user_sgpr_kernarg_segment_ptr 1
  .amdhsa_system_sgpr_workgroup_id_x 1
.end_amdhsa_kernel
```
